```python
import torch

def _softmax(x, axis=-1):
    return torch.softmax(x, dim=axis)
def _gelu(x):
    return torch.nn.functional.gelu(x, approximate="tanh")
def _silu(x):
    return torch.nn.functional.silu(x)
def _sigmoid(x):
    return torch.sigmoid(x)
def _layernorm(x, axis=-1, eps=1e-5):
    m = x.mean(dim=axis, keepdim=True)
    v = x.var(dim=axis, keepdim=True, unbiased=False)
    return (x - m) / torch.sqrt(v + eps)
def _scatter_add(tgt, idx, src, axis=0):
    return tgt.clone().index_add_(axis, idx, src)
def _segment_sum(src, seg, n):
    out = torch.zeros((n,) + src.shape[1:], dtype=src.dtype)
    return out.index_add_(0, seg, src)
def _pad(x, pw):
    flat = tuple(v for pair in reversed(pw) for v in pair)
    return torch.nn.functional.pad(x, flat)

kernel_name = 'interleave_layers__linear_kernel_hedgehog__mixer_token_mlp__prompt'

def setup_inputs():

    _w = (lambda a: (lambda t: t.to(torch.bfloat16) if t.is_floating_point() else t)(torch.as_tensor(a)))
    def _A_setup():
        B, S, D, H = 1, 2048, 640, 32
        Dh = D // H
        return {
            "x": _w((lambda *s: torch.randn(*s, dtype=torch.bfloat16) * 0.05)(B, S, D)),
            "wqkv": _w((lambda *s: torch.randn(*s, dtype=torch.bfloat16) * 0.4)(D, 3 * D)),
            "w_phi": _w((lambda *s: torch.randn(*s, dtype=torch.bfloat16) * 0.4)(H, Dh, Dh) * (Dh ** -0.5)),
            "wo": _w((lambda *s: torch.randn(*s, dtype=torch.bfloat16) * 0.05)(D, D)),
        }
    _A_in = _A_setup()

    def _B_setup():
        B, S, D, F = 1, 2048, 640, 1536
        return {
            "x": _w((lambda *s: torch.randn(*s, dtype=torch.bfloat16) * 0.05)(B, S, D)),
            "w1": _w((lambda *s: torch.randn(*s, dtype=torch.bfloat16) * 0.8)(S, F) * (S ** -0.5)),
            "b1": _w((lambda *s: torch.randn(*s, dtype=torch.bfloat16) * 0.8)(F) * 0.02),
            "w2": _w((lambda *s: torch.randn(*s, dtype=torch.bfloat16) * 0.8)(F, S) * (F ** -0.5)),
            "b2": _w((lambda *s: torch.randn(*s, dtype=torch.bfloat16) * 0.8)(S) * 0.02),
        }
    _B_in = _B_setup()

    return {
        "A_x": _A_in["x"],
        "A_wqkv": _A_in["wqkv"],
        "A_w_phi": _A_in["w_phi"],
        "A_wo": _A_in["wo"],
        "B_x": _B_in["x"],
        "B_w1": _B_in["w1"],
        "B_b1": _B_in["b1"],
        "B_w2": _B_in["w2"],
        "B_b2": _B_in["b2"],
    }

def reference(A_x, A_wqkv, A_w_phi, A_wo, B_x, B_w1, B_b1, B_w2, B_b2):
    def _A_ref(x, wqkv, w_phi, wo):
        B, S, D = x.shape
        H = 32; Dh = D // H
        qkv = (lambda x, *d: x.permute(*d))((x @ wqkv).reshape(B, S, 3, H, Dh), 2, 0, 3, 1, 4)
        q, k, v = qkv[0], qkv[1], qkv[2]
        pq = torch.einsum("bhsd,hdf->bhsf", q, w_phi)
        pk = torch.einsum("bhsd,hdf->bhsf", k, w_phi)
        phi_q = torch.concatenate([_softmax(pq, axis=-1), _softmax(-pq, axis=-1)], axis=-1)
        phi_k = torch.concatenate([_softmax(pk, axis=-1), _softmax(-pk, axis=-1)], axis=-1)
        kv = torch.einsum("bhsf,bhsd->bhfd", phi_k, v)
        z  = torch.einsum("bhsf->bhf", phi_k)
        num = torch.einsum("bhqf,bhfd->bhqd", phi_q, kv)
        den = torch.einsum("bhqf,bhf->bhq", phi_q, z)[..., None] + 1e-6
        o = num / den
        return (lambda x, *d: x.permute(*d))(o, 0, 2, 1, 3).reshape(B, S, D) @ wo

    def _B_ref(x, w1, b1, w2, b2):
        B, S, D = x.shape
        h = _layernorm(x, axis=-1)
        u = torch.einsum("bsd,sf->bdf", h, w1) + b1
        u = _gelu(u)
        y = torch.einsum("bdf,fs->bds", u, w2) + b2
        return (lambda x, *d: x.permute(*d))(y, 0, 2, 1)

    x = A_x
    x = x + _A_ref(_layernorm(x, axis=-1), A_wqkv, A_w_phi, A_wo)
    x = x + _B_ref(_layernorm(x, axis=-1), B_w1, B_b1, B_w2, B_b2)
    x = x + _A_ref(_layernorm(x, axis=-1), A_wqkv, A_w_phi, A_wo)
    x = x + _B_ref(_layernorm(x, axis=-1), B_w1, B_b1, B_w2, B_b2)
    return x
```

```asm
; @launch grid=(256,1,1) block=(256,1,1) lds=163840
.amdgcn_target "amdgcn-amd-amdhsa--gfx950"
.text
.globl interleave_layers__linear_kernel_hedgehog__mixer_token_mlp__prompt_kernel
.p2align 8
.type interleave_layers__linear_kernel_hedgehog__mixer_token_mlp__prompt_kernel,@function
interleave_layers__linear_kernel_hedgehog__mixer_token_mlp__prompt_kernel:
s_cmp_ge_u32 s2, 256
s_cbranch_scc1 mn_end
s_load_dwordx2 s[84:85], s[0:1], 8
s_load_dwordx2 s[88:89], s[0:1], 16
s_load_dwordx2 s[92:93], s[0:1], 24
s_load_dwordx2 s[44:45], s[0:1], 0
s_load_dwordx2 s[8:9], s[0:1], 88
s_load_dwordx2 s[60:61], s[0:1], 40
s_load_dwordx2 s[64:65], s[0:1], 56
s_load_dwordx2 s[12:13], s[0:1], 48
s_load_dwordx2 s[16:17], s[0:1], 64
s_load_dwordx2 s[40:41], s[0:1], 72
v_lshrrev_b32 v2, 6, v0
v_and_b32 v1, 63, v0
v_readfirstlane_b32 s20, v2
s_mov_b32 s86, 2457600
s_mov_b32 s87, 0x20000
s_mov_b32 s90, 25600
s_mov_b32 s91, 0x20000
s_mov_b32 s94, 819200
s_mov_b32 s95, 0x20000
s_mov_b32 s46, 2621440
s_mov_b32 s47, 0x20000
s_mov_b32 s10, 268435456
s_mov_b32 s11, 0x20000
s_mov_b32 s62, 6291456
s_mov_b32 s63, 0x20000
s_mov_b32 s66, 6291456
s_mov_b32 s67, 0x20000
s_mov_b32 s14, 3072
s_mov_b32 s15, 0x20000
s_mov_b32 s18, 4096
s_mov_b32 s19, 0x20000
s_mov_b32 s42, 2621440
s_mov_b32 s43, 0x20000
s_and_b32 s3, s2, 1
s_lshl_b32 s3, s3, 3
s_bfe_u32 s4, s2, 0x30003
s_add_u32 s21, s3, s4
s_bfe_u32 s3, s2, 0x20001
s_lshl_b32 s3, s3, 2
s_lshr_b32 s4, s2, 6
s_add_u32 s22, s3, s4
s_bfe_u32 s3, s2, 0x20001
s_lshl_b32 s3, s3, 3
s_bfe_u32 s4, s2, 0x30003
s_add_u32 s4, s4, 0
s_and_b32 s4, s4, 7
s_add_u32 s23, s3, s4
s_and_b32 s3, s2, 1
s_lshl_b32 s3, s3, 2
s_lshr_b32 s4, s2, 6
s_add_u32 s24, s3, s4
s_mul_i32 s29, s22, 167936
s_mov_b32 s27, 4194304
s_mov_b32 s28, 0
s_mov_b32 s5, 16826368
v_mov_b32 v254, 0x40000000
v_mov_b32 v255, 0
v_mov_b32 v235, 0
s_waitcnt lgkmcnt(0)
s_load_dword s68, s[8:9], s5
s_cmp_ge_u32 s2, 80
s_cbranch_scc1 mn_jwo
s_mul_i32 s54, s2, 205
s_lshr_b32 s54, s54, 10
s_mul_i32 s55, s54, 5
s_sub_u32 s55, s2, s55
s_lshl_b32 s56, s55, 2
s_add_u32 s56, s56, s20
v_and_b32 v2, 31, v1
v_lshrrev_b32 v3, 5, v1
v_and_b32 v4, 19, v2
v_bfe_u32 v5, v2, 2, 1
v_bfe_u32 v6, v2, 3, 1
v_lshl_or_b32 v4, v5, 3, v4
v_lshl_or_b32 v4, v6, 2, v4
s_lshl_b32 s3, s56, 5
v_add_u32 v4, s3, v4
v_mul_u32_u24 v4, 3840, v4
v_add_u32 v5, 64, v4
v_lshl_add_u32 v4, v3, 4, v4
s_mul_i32 s4, s54, 80
s_add_u32 s5, s4, 1280
s_add_u32 s6, s4, 2560
buffer_load_dwordx4 v[32:35], v4, s[84:87], s5 offen
buffer_load_dwordx4 v[36:39], v4, s[84:87], s5 offen offset:32
buffer_load_dwordx4 v[40:43], v5, s[84:87], s5 offen
buffer_load_dwordx4 v[44:47], v4, s[84:87], s6 offen
buffer_load_dwordx4 v[48:51], v4, s[84:87], s6 offen offset:32
buffer_load_dwordx4 v[52:55], v5, s[84:87], s6 offen
buffer_load_dwordx4 v[56:59], v4, s[84:87], s4 offen
buffer_load_dwordx4 v[60:63], v4, s[84:87], s4 offen offset:32
buffer_load_dwordx4 v[64:67], v5, s[84:87], s4 offen
s_mul_i32 s7, s54, 1600
v_lshlrev_b32 v6, 3, v0
buffer_load_dwordx2 v[8:9], v6, s[88:91], s7 offen
v_mov_b32 v12, 0
v_mov_b32 v13, 0
v_mov_b32 v14, 0
v_mov_b32 v15, 0
v_lshlrev_b32 v7, 4, v0
ds_write_b128 v7, v[12:15]
ds_write_b128 v7, v[12:15] offset:4096
v_cmp_le_u32 vcc, 100, v0
s_nop 1
v_cndmask_b32 v10, 0, 1, vcc
v_mul_u32_u24 v11, 100, v10
v_sub_u32 v11, v0, v11
v_mul_u32_u24 v16, 205, v11
v_lshrrev_b32 v16, 10, v16
v_mul_u32_u24 v17, 5, v16
v_sub_u32 v17, v11, v17
v_mul_u32_u24 v17, 384, v17
v_mul_u32_u24 v18, 1960, v10
v_add_u32 v17, v17, v18
v_lshl_add_u32 v17, v16, 1, v17
v_mul_u32_u24 v18, 98, v0
v_add_u32 v18, 3840, v18
v_mov_b32 v19, 0x3f80
v_lshrrev_b32 v20, 3, v2
v_bfe_u32 v21, v2, 2, 1
v_and_b32 v22, 3, v2
v_mul_u32_u24 v21, 20, v21
v_add_u32 v21, v21, v22
v_mul_u32_u24 v21, 96, v21
v_lshlrev_b32 v23, 4, v3
v_add_u32 v21, v21, v23
v_add_u32 v23, 7680, v23
v_add_u32 v22, 0, v20
v_cmp_gt_u32 vcc, 5, v22
v_mul_u32_u24 v22, 384, v22
v_add_u32 v22, v22, v21
v_cndmask_b32 v24, v23, v22, vcc
v_add_u32 v22, 4, v20
v_cmp_gt_u32 vcc, 5, v22
v_mul_u32_u24 v22, 384, v22
v_add_u32 v22, v22, v21
v_cndmask_b32 v25, v23, v22, vcc
v_add_u32 v22, -1, v20
v_cmp_gt_u32 vcc, 5, v22
v_mul_u32_u24 v22, 384, v22
v_add_u32 v22, v22, v21
v_add_u32 v22, 3840, v22
v_cndmask_b32 v26, v23, v22, vcc
v_add_u32 v22, 3, v20
v_cmp_gt_u32 vcc, 5, v22
v_mul_u32_u24 v22, 384, v22
v_add_u32 v22, v22, v21
v_add_u32 v22, 3840, v22
v_cndmask_b32 v27, v23, v22, vcc
v_add_u32 v22, -2, v20
v_cmp_gt_u32 vcc, 5, v22
v_mul_u32_u24 v22, 384, v22
v_add_u32 v22, v22, v21
v_cndmask_b32 v28, v23, v22, vcc
v_add_u32 v22, 2, v20
v_cmp_gt_u32 vcc, 5, v22
v_mul_u32_u24 v22, 384, v22
v_add_u32 v22, v22, v21
v_cndmask_b32 v29, v23, v22, vcc
v_add_u32 v213, 0, v1
v_mul_u32_u24 v214, 205, v213
v_lshrrev_b32 v214, 13, v214
v_xor_b32 v213, v213, v214
v_mul_u32_u24 v214, 640, v214
v_lshl_add_u32 v208, v213, 4, v214
v_add_u32 v213, 64, v1
v_mul_u32_u24 v214, 205, v213
v_lshrrev_b32 v214, 13, v214
v_xor_b32 v213, v213, v214
v_mul_u32_u24 v214, 640, v214
v_lshl_add_u32 v209, v213, 4, v214
v_add_u32 v213, 128, v1
v_mul_u32_u24 v214, 205, v213
v_lshrrev_b32 v214, 13, v214
v_xor_b32 v213, v213, v214
v_mul_u32_u24 v214, 640, v214
v_lshl_add_u32 v210, v213, 4, v214
v_add_u32 v213, 192, v1
v_mul_u32_u24 v214, 205, v213
v_lshrrev_b32 v214, 13, v214
v_xor_b32 v213, v213, v214
v_mul_u32_u24 v214, 640, v214
v_lshl_add_u32 v211, v213, 4, v214
v_add_u32 v213, 256, v1
v_mul_u32_u24 v214, 205, v213
v_lshrrev_b32 v214, 13, v214
v_xor_b32 v213, v213, v214
v_mul_u32_u24 v214, 640, v214
v_lshl_add_u32 v212, v213, 4, v214
s_lshl_b32 s59, s21, 2
s_add_u32 s59, s59, s20
s_mul_i32 s59, s59, 40960
s_add_u32 s59, s59, 0
s_mul_i32 s98, s20, 20480
s_add_u32 s98, s98, 81920
s_add_u32 m0, s98, 0
s_nop 0
buffer_load_dwordx4 v208, s[44:47], s59 offen lds
s_add_u32 m0, s98, 1024
s_nop 0
buffer_load_dwordx4 v209, s[44:47], s59 offen lds
s_add_u32 m0, s98, 2048
s_nop 0
buffer_load_dwordx4 v210, s[44:47], s59 offen lds
s_add_u32 m0, s98, 3072
s_nop 0
buffer_load_dwordx4 v211, s[44:47], s59 offen lds
s_add_u32 m0, s98, 4096
s_nop 0
buffer_load_dwordx4 v212, s[44:47], s59 offen lds
s_add_u32 s59, s59, 10240
s_add_u32 m0, s98, 5120
s_nop 0
buffer_load_dwordx4 v208, s[44:47], s59 offen lds
s_add_u32 m0, s98, 6144
s_nop 0
buffer_load_dwordx4 v209, s[44:47], s59 offen lds
s_add_u32 m0, s98, 7168
s_nop 0
buffer_load_dwordx4 v210, s[44:47], s59 offen lds
s_add_u32 m0, s98, 8192
s_nop 0
buffer_load_dwordx4 v211, s[44:47], s59 offen lds
s_add_u32 m0, s98, 9216
s_nop 0
buffer_load_dwordx4 v212, s[44:47], s59 offen lds
s_add_u32 s59, s59, 10240
s_add_u32 m0, s98, 10240
s_nop 0
buffer_load_dwordx4 v208, s[44:47], s59 offen lds
s_add_u32 m0, s98, 11264
s_nop 0
buffer_load_dwordx4 v209, s[44:47], s59 offen lds
s_add_u32 m0, s98, 12288
s_nop 0
buffer_load_dwordx4 v210, s[44:47], s59 offen lds
s_add_u32 m0, s98, 13312
s_nop 0
buffer_load_dwordx4 v211, s[44:47], s59 offen lds
s_add_u32 m0, s98, 14336
s_nop 0
buffer_load_dwordx4 v212, s[44:47], s59 offen lds
s_add_u32 s59, s59, 10240
s_add_u32 m0, s98, 15360
s_nop 0
buffer_load_dwordx4 v208, s[44:47], s59 offen lds
s_add_u32 m0, s98, 16384
s_nop 0
buffer_load_dwordx4 v209, s[44:47], s59 offen lds
s_add_u32 m0, s98, 17408
s_nop 0
buffer_load_dwordx4 v210, s[44:47], s59 offen lds
s_add_u32 m0, s98, 18432
s_nop 0
buffer_load_dwordx4 v211, s[44:47], s59 offen lds
s_add_u32 m0, s98, 19456
s_nop 0
buffer_load_dwordx4 v212, s[44:47], s59 offen lds
s_waitcnt lgkmcnt(0)
s_barrier
s_waitcnt vmcnt(20)
v_cmp_gt_u32 vcc, 200, v0
s_nop 0
s_and_saveexec_b64 s[96:97], vcc
s_cbranch_execz mn_jnophi
ds_write_b16 v17, v8
ds_write_b16_d16_hi v17, v8 offset:96
ds_write_b16 v17, v9 offset:192
ds_write_b16_d16_hi v17, v9 offset:288
v_cmp_gt_u32 vcc, 40, v0
s_nop 0
s_and_b64 exec, exec, vcc
s_cbranch_execz mn_jnophi
ds_write_b16 v18, v19
mn_jnophi:
s_mov_b64 exec, -1
s_waitcnt lgkmcnt(0)
s_barrier
ds_read_b128 v[68:71], v24 offset:0
ds_read_b128 v[72:75], v24 offset:32
ds_read_b128 v[76:79], v24 offset:64
ds_read_b128 v[80:83], v25 offset:0
ds_read_b128 v[84:87], v25 offset:32
ds_read_b128 v[88:91], v25 offset:64
ds_read_b128 v[92:95], v26 offset:0
ds_read_b128 v[96:99], v26 offset:32
ds_read_b128 v[100:103], v26 offset:64
ds_read_b128 v[104:107], v27 offset:0
ds_read_b128 v[108:111], v27 offset:32
ds_read_b128 v[112:115], v27 offset:64
s_waitcnt lgkmcnt(8)
ds_read_b128 v[116:119], v28 offset:0
ds_read_b128 v[120:123], v28 offset:32
ds_read_b128 v[124:127], v28 offset:64
ds_read_b128 v[128:131], v29 offset:0
ds_read_b128 v[132:135], v29 offset:32
ds_read_b128 v[136:139], v29 offset:64
s_waitcnt lgkmcnt(0)
s_waitcnt vmcnt(21)
v_mfma_f32_32x32x16_bf16 v[144:159], v[32:35], v[68:71], 0
v_mfma_f32_32x32x16_bf16 v[160:175], v[32:35], v[80:83], 0
v_mfma_f32_32x32x16_bf16 v[160:175], v[44:47], v[92:95], v[160:175]
v_mfma_f32_32x32x16_bf16 v[176:191], v[44:47], v[104:107], 0
v_mfma_f32_32x32x16_bf16 v[176:191], v[56:59], v[116:119], v[176:191]
v_mfma_f32_32x32x16_bf16 v[192:207], v[56:59], v[128:131], 0
v_mfma_f32_32x32x16_bf16 v[144:159], v[36:39], v[72:75], v[144:159]
v_mfma_f32_32x32x16_bf16 v[160:175], v[36:39], v[84:87], v[160:175]
v_mfma_f32_32x32x16_bf16 v[160:175], v[48:51], v[96:99], v[160:175]
v_mfma_f32_32x32x16_bf16 v[176:191], v[48:51], v[108:111], v[176:191]
v_mfma_f32_32x32x16_bf16 v[176:191], v[60:63], v[120:123], v[176:191]
v_mfma_f32_32x32x16_bf16 v[192:207], v[60:63], v[132:135], v[192:207]
v_mfma_f32_32x32x16_bf16 v[144:159], v[40:43], v[76:79], v[144:159]
v_mfma_f32_32x32x16_bf16 v[160:175], v[40:43], v[88:91], v[160:175]
v_mfma_f32_32x32x16_bf16 v[160:175], v[52:55], v[100:103], v[160:175]
v_mfma_f32_32x32x16_bf16 v[176:191], v[52:55], v[112:115], v[176:191]
v_mfma_f32_32x32x16_bf16 v[176:191], v[64:67], v[124:127], v[176:191]
v_mfma_f32_32x32x16_bf16 v[192:207], v[64:67], v[136:139], v[192:207]
s_mul_i32 s32, s54, 167936
s_mul_i32 s33, s56, 6144
s_add_u32 s33, s33, s32
s_lshl_b32 s34, s56, 11
s_add_u32 s34, s34, s32
s_add_u32 s34, s34, 122880
v_lshlrev_b32 v4, 4, v1
v_mov_b32 v5, 0x3f803f80
v_cvt_pk_bf16_f32 v32, v144, v145
v_cvt_pk_bf16_f32 v33, v146, v147
v_cvt_pk_bf16_f32 v34, v148, v149
v_cvt_pk_bf16_f32 v35, v150, v151
v_cvt_pk_bf16_f32 v36, v152, v153
v_cvt_pk_bf16_f32 v37, v154, v155
v_cvt_pk_bf16_f32 v38, v156, v157
v_cvt_pk_bf16_f32 v39, v158, v159
buffer_store_dwordx4 v[32:35], v4, s[8:11], s33 offen sc1
buffer_store_dwordx4 v[36:39], v4, s[8:11], s33 offen offset:3072 sc1
v_cvt_pk_bf16_f32 v40, v160, v161
v_cvt_pk_bf16_f32 v41, v162, v163
v_cvt_pk_bf16_f32 v42, v164, v165
v_cvt_pk_bf16_f32 v43, v166, v167
v_cvt_pk_bf16_f32 v44, v168, v169
v_cvt_pk_bf16_f32 v45, v170, v171
v_cvt_pk_bf16_f32 v46, v172, v173
v_cvt_pk_bf16_f32 v47, v174, v175
buffer_store_dwordx4 v[40:43], v4, s[8:11], s33 offen offset:1024 sc1
s_add_u32 s99, s33, 4096
buffer_store_dwordx4 v[44:47], v4, s[8:11], s99 offen sc1
v_cvt_pk_bf16_f32 v48, v176, v177
v_cvt_pk_bf16_f32 v49, v178, v179
v_cvt_pk_bf16_f32 v50, v180, v181
v_cvt_pk_bf16_f32 v51, v182, v183
v_cvt_pk_bf16_f32 v52, v184, v185
v_cvt_pk_bf16_f32 v53, v186, v187
v_cvt_pk_bf16_f32 v54, v188, v189
v_cvt_pk_bf16_f32 v55, v190, v191
buffer_store_dwordx4 v[48:51], v4, s[8:11], s33 offen offset:2048 sc1
buffer_store_dwordx4 v[52:55], v4, s[8:11], s99 offen offset:1024 sc1
v_cvt_pk_bf16_f32 v56, v192, v193
v_cvt_pk_bf16_f32 v57, v194, v195
v_cvt_pk_bf16_f32 v58, v196, v197
v_cvt_pk_bf16_f32 v59, v198, v199
v_cvt_pk_bf16_f32 v60, v200, v201
v_cvt_pk_bf16_f32 v61, v202, v203
v_cvt_pk_bf16_f32 v62, v204, v205
v_cvt_pk_bf16_f32 v63, v206, v207
buffer_store_dwordx4 v[56:59], v4, s[8:11], s34 offen sc1
buffer_store_dwordx4 v[60:63], v4, s[8:11], s34 offen offset:1024 sc1
v_mov_b32 v8, 0
v_mov_b32 v9, 0
v_mov_b32 v10, 0
v_mov_b32 v11, 0
v_dot2c_f32_bf16 v8, v32, v5
v_dot2c_f32_bf16 v9, v40, v5
v_dot2c_f32_bf16 v10, v48, v5
v_dot2c_f32_bf16 v11, v56, v5
v_dot2c_f32_bf16 v8, v33, v5
v_dot2c_f32_bf16 v9, v41, v5
v_dot2c_f32_bf16 v10, v49, v5
v_dot2c_f32_bf16 v11, v57, v5
v_dot2c_f32_bf16 v8, v34, v5
v_dot2c_f32_bf16 v9, v42, v5
v_dot2c_f32_bf16 v10, v50, v5
v_dot2c_f32_bf16 v11, v58, v5
v_dot2c_f32_bf16 v8, v35, v5
v_dot2c_f32_bf16 v9, v43, v5
v_dot2c_f32_bf16 v10, v51, v5
v_dot2c_f32_bf16 v11, v59, v5
v_dot2c_f32_bf16 v8, v36, v5
v_dot2c_f32_bf16 v9, v44, v5
v_dot2c_f32_bf16 v10, v52, v5
v_dot2c_f32_bf16 v11, v60, v5
v_dot2c_f32_bf16 v8, v37, v5
v_dot2c_f32_bf16 v9, v45, v5
v_dot2c_f32_bf16 v10, v53, v5
v_dot2c_f32_bf16 v11, v61, v5
v_dot2c_f32_bf16 v8, v38, v5
v_dot2c_f32_bf16 v9, v46, v5
v_dot2c_f32_bf16 v10, v54, v5
v_dot2c_f32_bf16 v11, v62, v5
v_dot2c_f32_bf16 v8, v39, v5
v_dot2c_f32_bf16 v9, v47, v5
v_dot2c_f32_bf16 v10, v55, v5
v_dot2c_f32_bf16 v11, v63, v5
s_lshl_b32 s3, s20, 10
v_lshl_add_u32 v6, v1, 2, s3
ds_write_b32 v6, v8 offset:8192
ds_write_b32 v6, v9 offset:8448
ds_write_b32 v6, v10 offset:8704
ds_write_b32 v6, v11 offset:8960
s_lshl_b32 s3, s20, 8
v_lshl_add_u32 v6, v2, 2, s3
s_waitcnt lgkmcnt(0)
s_barrier
ds_read_b32 v12, v6 offset:8192
ds_read_b32 v13, v6 offset:8320
ds_read_b32 v14, v6 offset:9216
ds_read_b32 v15, v6 offset:9344
ds_read_b32 v16, v6 offset:10240
ds_read_b32 v17, v6 offset:10368
ds_read_b32 v18, v6 offset:11264
ds_read_b32 v19, v6 offset:11392
s_waitcnt lgkmcnt(0)
v_add_f32 v12, v12, v13
v_add_f32 v14, v14, v15
v_add_f32 v16, v16, v17
v_add_f32 v18, v18, v19
v_add_f32 v12, v12, v14
v_add_f32 v16, v16, v18
v_add_f32 v12, v12, v16
v_cvt_pk_bf16_f32 v13, v12, v12
v_lshlrev_b32 v14, 16, v13
v_sub_f32 v14, v12, v14
v_cvt_pk_bf16_f32 v14, v14, v14
v_mov_b32 v15, 0
v_lshlrev_b32 v6, 4, v2
s_lshl_b32 s3, s20, 10
s_add_u32 s35, s32, s3
s_add_u32 s35, s35, 163840
s_mul_i32 s36, s55, 3
s_mov_b64 exec, 0xffffffff
s_add_u32 s37, s36, 0
s_lshr_b32 s38, s37, 3
s_lshl_b32 s38, s38, 9
s_and_b32 s37, s37, 7
s_lshl_b32 s37, s37, 1
s_add_u32 s37, s37, s38
s_add_u32 s37, s37, s35
buffer_store_short v13, v6, s[8:11], s37 offen sc1
s_add_u32 s37, s36, 1
s_lshr_b32 s38, s37, 3
s_lshl_b32 s38, s38, 9
s_and_b32 s37, s37, 7
s_lshl_b32 s37, s37, 1
s_add_u32 s37, s37, s38
s_add_u32 s37, s37, s35
buffer_store_short v14, v6, s[8:11], s37 offen sc1
s_add_u32 s37, s36, 2
s_lshr_b32 s38, s37, 3
s_lshl_b32 s38, s38, 9
s_and_b32 s37, s37, 7
s_lshl_b32 s37, s37, 1
s_add_u32 s37, s37, s38
s_add_u32 s37, s37, s35
buffer_store_short v13, v6, s[8:11], s37 offen sc1
s_cmp_lg_u32 s55, 4
s_cbranch_scc1 mn_jwpe
buffer_store_short v15, v6, s[8:11], s35 offen offset:526 sc1
mn_jwpe:
s_mov_b64 exec, -1
s_waitcnt lgkmcnt(0)
s_mul_i32 s69, s68, 0x9e3779b1
s_add_u32 s69, s69, 0x7f4a7c15
s_lshl_b32 s6, s2, 7
s_add_u32 s6, s6, 16793600
s_waitcnt vmcnt(0)
s_barrier
s_cmp_lg_u32 s20, 0
s_cbranch_scc1 mn_nf1
s_mov_b64 exec, 1
v_mov_b32 v30, s69
buffer_store_dword v30, v255, s[8:11], s6 offen sc1
s_mov_b64 exec, -1
mn_nf1:
s_branch mn_jend
mn_jwo:
s_cmp_ge_u32 s2, 130
s_cbranch_scc1 mn_jst
s_sub_u32 s54, s2, 80
s_lshl_b32 s54, s54, 2
s_add_u32 s54, s54, s20
s_mul_i32 s55, s54, 205
s_lshr_b32 s55, s55, 11
s_mul_i32 s56, s55, 10
s_sub_u32 s56, s54, s56
v_and_b32 v2, 31, v1
v_lshrrev_b32 v3, 5, v1
v_and_b32 v4, 19, v2
v_bfe_u32 v5, v2, 2, 1
v_bfe_u32 v6, v2, 3, 1
v_lshl_or_b32 v4, v5, 3, v4
v_lshl_or_b32 v4, v6, 2, v4
s_lshl_b32 s3, s55, 5
v_add_u32 v4, s3, v4
v_mul_u32_u24 v5, 1639, v4
v_lshrrev_b32 v5, 16, v5
v_mul_u32_u24 v5, 40, v5
v_sub_u32 v6, v4, v5
v_add_u32 v7, -16, v6
v_cmp_gt_u32 vcc, 16, v7
s_nop 1
v_cndmask_b32 v8, 0, 4, vcc
v_add_u32 v7, -32, v6
v_cmp_gt_u32 vcc, 4, v7
s_nop 1
v_cndmask_b32 v9, 0, -16, vcc
v_add3_u32 v4, v4, v8, v9
v_mul_u32_u24 v4, 1280, v4
v_lshl_add_u32 v4, v3, 4, v4
s_lshl_b32 s4, s56, 7
buffer_load_dwordx4 v[32:35], v4, s[92:95], s4 offen
buffer_load_dwordx4 v[36:39], v4, s[92:95], s4 offen offset:32
buffer_load_dwordx4 v[40:43], v4, s[92:95], s4 offen offset:64
buffer_load_dwordx4 v[44:47], v4, s[92:95], s4 offen offset:96
v_and_b32 v5, 1, v2
v_cmp_eq_u32 vcc, 1, v5
v_mov_b32 v6, 0x3f80
v_mov_b32 v7, 0x3f800000
v_cndmask_b32 v6, v6, v7, vcc
v_lshrrev_b32 v5, 1, v2
v_lshlrev_b32 v7, 2, v3
v_sub_u32 v5, v5, v7
v_cmp_eq_u32 vcc, 0, v5
s_nop 1
v_cndmask_b32 v16, 0, v6, vcc
v_cmp_eq_u32 vcc, 1, v5
s_nop 1
v_cndmask_b32 v17, 0, v6, vcc
v_cmp_eq_u32 vcc, 2, v5
s_nop 1
v_cndmask_b32 v18, 0, v6, vcc
v_cmp_eq_u32 vcc, 3, v5
s_nop 1
v_cndmask_b32 v19, 0, v6, vcc
v_cmp_eq_u32 vcc, 8, v5
s_nop 1
v_cndmask_b32 v20, 0, v6, vcc
v_cmp_eq_u32 vcc, 9, v5
s_nop 1
v_cndmask_b32 v21, 0, v6, vcc
v_cmp_eq_u32 vcc, 10, v5
s_nop 1
v_cndmask_b32 v22, 0, v6, vcc
v_cmp_eq_u32 vcc, 11, v5
s_nop 1
v_cndmask_b32 v23, 0, v6, vcc
v_lshrrev_b32 v8, 4, v2
v_mul_u32_u24 v8, 20480, v8
v_lshl_add_u32 v8, v3, 8, v8
v_and_b32 v9, 15, v2
v_lshl_add_u32 v8, v9, 4, v8
s_mul_i32 s5, s56, 81920
s_lshl_b32 s6, s55, 10
s_add_u32 s5, s5, s6
s_add_u32 s5, s5, 3145728
v_add_u32 v213, 0, v1
v_mul_u32_u24 v214, 205, v213
v_lshrrev_b32 v214, 13, v214
v_xor_b32 v213, v213, v214
v_mul_u32_u24 v214, 640, v214
v_lshl_add_u32 v208, v213, 4, v214
v_add_u32 v213, 64, v1
v_mul_u32_u24 v214, 205, v213
v_lshrrev_b32 v214, 13, v214
v_xor_b32 v213, v213, v214
v_mul_u32_u24 v214, 640, v214
v_lshl_add_u32 v209, v213, 4, v214
v_add_u32 v213, 128, v1
v_mul_u32_u24 v214, 205, v213
v_lshrrev_b32 v214, 13, v214
v_xor_b32 v213, v213, v214
v_mul_u32_u24 v214, 640, v214
v_lshl_add_u32 v210, v213, 4, v214
v_add_u32 v213, 192, v1
v_mul_u32_u24 v214, 205, v213
v_lshrrev_b32 v214, 13, v214
v_xor_b32 v213, v213, v214
v_mul_u32_u24 v214, 640, v214
v_lshl_add_u32 v211, v213, 4, v214
v_add_u32 v213, 256, v1
v_mul_u32_u24 v214, 205, v213
v_lshrrev_b32 v214, 13, v214
v_xor_b32 v213, v213, v214
v_mul_u32_u24 v214, 640, v214
v_lshl_add_u32 v212, v213, 4, v214
s_lshl_b32 s59, s21, 2
s_add_u32 s59, s59, s20
s_mul_i32 s59, s59, 40960
s_add_u32 s59, s59, 0
s_mul_i32 s98, s20, 20480
s_add_u32 s98, s98, 81920
s_add_u32 m0, s98, 0
s_nop 0
buffer_load_dwordx4 v208, s[44:47], s59 offen lds
s_add_u32 m0, s98, 1024
s_nop 0
buffer_load_dwordx4 v209, s[44:47], s59 offen lds
s_add_u32 m0, s98, 2048
s_nop 0
buffer_load_dwordx4 v210, s[44:47], s59 offen lds
s_add_u32 m0, s98, 3072
s_nop 0
buffer_load_dwordx4 v211, s[44:47], s59 offen lds
s_add_u32 m0, s98, 4096
s_nop 0
buffer_load_dwordx4 v212, s[44:47], s59 offen lds
s_add_u32 s59, s59, 10240
s_add_u32 m0, s98, 5120
s_nop 0
buffer_load_dwordx4 v208, s[44:47], s59 offen lds
s_add_u32 m0, s98, 6144
s_nop 0
buffer_load_dwordx4 v209, s[44:47], s59 offen lds
s_add_u32 m0, s98, 7168
s_nop 0
buffer_load_dwordx4 v210, s[44:47], s59 offen lds
s_add_u32 m0, s98, 8192
s_nop 0
buffer_load_dwordx4 v211, s[44:47], s59 offen lds
s_add_u32 m0, s98, 9216
s_nop 0
buffer_load_dwordx4 v212, s[44:47], s59 offen lds
s_add_u32 s59, s59, 10240
s_add_u32 m0, s98, 10240
s_nop 0
buffer_load_dwordx4 v208, s[44:47], s59 offen lds
s_add_u32 m0, s98, 11264
s_nop 0
buffer_load_dwordx4 v209, s[44:47], s59 offen lds
s_add_u32 m0, s98, 12288
s_nop 0
buffer_load_dwordx4 v210, s[44:47], s59 offen lds
s_add_u32 m0, s98, 13312
s_nop 0
buffer_load_dwordx4 v211, s[44:47], s59 offen lds
s_add_u32 m0, s98, 14336
s_nop 0
buffer_load_dwordx4 v212, s[44:47], s59 offen lds
s_add_u32 s59, s59, 10240
s_add_u32 m0, s98, 15360
s_nop 0
buffer_load_dwordx4 v208, s[44:47], s59 offen lds
s_add_u32 m0, s98, 16384
s_nop 0
buffer_load_dwordx4 v209, s[44:47], s59 offen lds
s_add_u32 m0, s98, 17408
s_nop 0
buffer_load_dwordx4 v210, s[44:47], s59 offen lds
s_add_u32 m0, s98, 18432
s_nop 0
buffer_load_dwordx4 v211, s[44:47], s59 offen lds
s_add_u32 m0, s98, 19456
s_nop 0
buffer_load_dwordx4 v212, s[44:47], s59 offen lds
s_waitcnt vmcnt(20)
v_mfma_f32_32x32x16_bf16 v[64:79], v[32:35], v[16:19], 0
v_mfma_f32_32x32x16_bf16 v[64:79], v[36:39], v[20:23], v[64:79]
v_mfma_f32_32x32x16_bf16 v[80:95], v[40:43], v[16:19], 0
v_mfma_f32_32x32x16_bf16 v[80:95], v[44:47], v[20:23], v[80:95]
s_nop 9
v_cvt_pk_bf16_f32 v96, v64, v65
v_cvt_pk_bf16_f32 v97, v66, v67
v_cvt_pk_bf16_f32 v98, v68, v69
v_cvt_pk_bf16_f32 v99, v70, v71
v_cvt_pk_bf16_f32 v100, v72, v73
v_cvt_pk_bf16_f32 v101, v74, v75
v_cvt_pk_bf16_f32 v102, v76, v77
v_cvt_pk_bf16_f32 v103, v78, v79
buffer_store_dwordx4 v[96:99], v8, s[8:11], s5 offen sc1
buffer_store_dwordx4 v[100:103], v8, s[8:11], s5 offen offset:512 sc1
v_cvt_pk_bf16_f32 v104, v80, v81
v_cvt_pk_bf16_f32 v105, v82, v83
v_cvt_pk_bf16_f32 v106, v84, v85
v_cvt_pk_bf16_f32 v107, v86, v87
v_cvt_pk_bf16_f32 v108, v88, v89
v_cvt_pk_bf16_f32 v109, v90, v91
v_cvt_pk_bf16_f32 v110, v92, v93
v_cvt_pk_bf16_f32 v111, v94, v95
s_add_u32 s99, s5, 40960
buffer_store_dwordx4 v[104:107], v8, s[8:11], s99 offen sc1
buffer_store_dwordx4 v[108:111], v8, s[8:11], s99 offen offset:512 sc1
v_mov_b32 v216, -1
v_mov_b32 v220, 0
v_mov_b32 v217, -1
v_mov_b32 v221, 0
v_mov_b32 v218, -1
v_mov_b32 v222, 0
v_mov_b32 v219, -1
v_mov_b32 v223, 0
v_lshlrev_b32 v213, 4, v0
v_mov_b32 v214, 0x40000000
v_cmp_gt_u32 vcc, 224, v0
s_nop 1
v_cndmask_b32 v215, v214, v213, vcc
s_sub_u32 s57, s2, 80
s_mul_i32 s57, s57, 6
s_add_u32 s57, s57, 0
s_min_u32 s57, s57, 255
s_mul_i32 s57, s57, 3584
s_add_u32 s57, s57, 15597568
buffer_store_dwordx4 v[216:219], v215, s[8:11], s57 offen sc1
s_sub_u32 s57, s2, 80
s_mul_i32 s57, s57, 6
s_add_u32 s57, s57, 1
s_min_u32 s57, s57, 255
s_mul_i32 s57, s57, 3584
s_add_u32 s57, s57, 15597568
buffer_store_dwordx4 v[216:219], v215, s[8:11], s57 offen sc1
s_sub_u32 s57, s2, 80
s_mul_i32 s57, s57, 6
s_add_u32 s57, s57, 2
s_min_u32 s57, s57, 255
s_mul_i32 s57, s57, 3584
s_add_u32 s57, s57, 15597568
buffer_store_dwordx4 v[216:219], v215, s[8:11], s57 offen sc1
s_sub_u32 s57, s2, 80
s_mul_i32 s57, s57, 6
s_add_u32 s57, s57, 3
s_min_u32 s57, s57, 255
s_mul_i32 s57, s57, 3584
s_add_u32 s57, s57, 15597568
buffer_store_dwordx4 v[216:219], v215, s[8:11], s57 offen sc1
s_sub_u32 s57, s2, 80
s_mul_i32 s57, s57, 6
s_add_u32 s57, s57, 4
s_min_u32 s57, s57, 255
s_mul_i32 s57, s57, 3584
s_add_u32 s57, s57, 15597568
buffer_store_dwordx4 v[216:219], v215, s[8:11], s57 offen sc1
s_sub_u32 s57, s2, 80
s_mul_i32 s57, s57, 6
s_add_u32 s57, s57, 5
s_min_u32 s57, s57, 255
s_mul_i32 s57, s57, 3584
s_add_u32 s57, s57, 15597568
buffer_store_dwordx4 v[216:219], v215, s[8:11], s57 offen sc1
s_waitcnt lgkmcnt(0)
s_mul_i32 s69, s68, 0x9e3779b1
s_add_u32 s69, s69, 0x7f4a7c15
s_lshl_b32 s6, s2, 7
s_add_u32 s6, s6, 16793600
s_waitcnt vmcnt(0)
s_barrier
s_cmp_lg_u32 s20, 0
s_cbranch_scc1 mn_nf2
s_mov_b64 exec, 1
v_mov_b32 v30, s69
buffer_store_dword v30, v255, s[8:11], s6 offen sc1
s_mov_b64 exec, -1
mn_nf2:
s_branch mn_jend
mn_jst:
s_cmp_ge_u32 s2, 194
s_cbranch_scc1 mn_jpf
s_sub_u32 s54, s2, 130
s_lshl_b32 s54, s54, 2
s_add_u32 s54, s54, s20
s_mul_i32 s55, s54, 10240
v_lshrrev_b32 v2, 3, v1
v_and_b32 v3, 7, v1
v_mul_u32_u24 v4, 1280, v2
v_lshl_add_u32 v4, v3, 4, v4
buffer_load_dwordx4 v[32:35], v4, s[44:47], s55 offen
buffer_load_dwordx4 v[36:39], v4, s[44:47], s55 offen offset:128
buffer_load_dwordx4 v[40:43], v4, s[44:47], s55 offen offset:256
buffer_load_dwordx4 v[44:47], v4, s[44:47], s55 offen offset:384
buffer_load_dwordx4 v[48:51], v4, s[44:47], s55 offen offset:512
buffer_load_dwordx4 v[52:55], v4, s[44:47], s55 offen offset:640
buffer_load_dwordx4 v[56:59], v4, s[44:47], s55 offen offset:768
buffer_load_dwordx4 v[60:63], v4, s[44:47], s55 offen offset:896
buffer_load_dwordx4 v[64:67], v4, s[44:47], s55 offen offset:1024
buffer_load_dwordx4 v[68:71], v4, s[44:47], s55 offen offset:1152
v_add_u32 v213, 0, v1
v_mul_u32_u24 v214, 205, v213
v_lshrrev_b32 v214, 13, v214
v_xor_b32 v213, v213, v214
v_mul_u32_u24 v214, 640, v214
v_lshl_add_u32 v208, v213, 4, v214
v_add_u32 v213, 64, v1
v_mul_u32_u24 v214, 205, v213
v_lshrrev_b32 v214, 13, v214
v_xor_b32 v213, v213, v214
v_mul_u32_u24 v214, 640, v214
v_lshl_add_u32 v209, v213, 4, v214
v_add_u32 v213, 128, v1
v_mul_u32_u24 v214, 205, v213
v_lshrrev_b32 v214, 13, v214
v_xor_b32 v213, v213, v214
v_mul_u32_u24 v214, 640, v214
v_lshl_add_u32 v210, v213, 4, v214
v_add_u32 v213, 192, v1
v_mul_u32_u24 v214, 205, v213
v_lshrrev_b32 v214, 13, v214
v_xor_b32 v213, v213, v214
v_mul_u32_u24 v214, 640, v214
v_lshl_add_u32 v211, v213, 4, v214
v_add_u32 v213, 256, v1
v_mul_u32_u24 v214, 205, v213
v_lshrrev_b32 v214, 13, v214
v_xor_b32 v213, v213, v214
v_mul_u32_u24 v214, 640, v214
v_lshl_add_u32 v212, v213, 4, v214
s_lshl_b32 s59, s21, 2
s_add_u32 s59, s59, s20
s_mul_i32 s59, s59, 40960
s_add_u32 s59, s59, 0
s_mul_i32 s98, s20, 20480
s_add_u32 s98, s98, 81920
s_add_u32 m0, s98, 0
s_nop 0
buffer_load_dwordx4 v208, s[44:47], s59 offen lds
s_add_u32 m0, s98, 1024
s_nop 0
buffer_load_dwordx4 v209, s[44:47], s59 offen lds
s_add_u32 m0, s98, 2048
s_nop 0
buffer_load_dwordx4 v210, s[44:47], s59 offen lds
s_add_u32 m0, s98, 3072
s_nop 0
buffer_load_dwordx4 v211, s[44:47], s59 offen lds
s_add_u32 m0, s98, 4096
s_nop 0
buffer_load_dwordx4 v212, s[44:47], s59 offen lds
s_add_u32 s59, s59, 10240
s_add_u32 m0, s98, 5120
s_nop 0
buffer_load_dwordx4 v208, s[44:47], s59 offen lds
s_add_u32 m0, s98, 6144
s_nop 0
buffer_load_dwordx4 v209, s[44:47], s59 offen lds
s_add_u32 m0, s98, 7168
s_nop 0
buffer_load_dwordx4 v210, s[44:47], s59 offen lds
s_add_u32 m0, s98, 8192
s_nop 0
buffer_load_dwordx4 v211, s[44:47], s59 offen lds
s_add_u32 m0, s98, 9216
s_nop 0
buffer_load_dwordx4 v212, s[44:47], s59 offen lds
s_add_u32 s59, s59, 10240
s_add_u32 m0, s98, 10240
s_nop 0
buffer_load_dwordx4 v208, s[44:47], s59 offen lds
s_add_u32 m0, s98, 11264
s_nop 0
buffer_load_dwordx4 v209, s[44:47], s59 offen lds
s_add_u32 m0, s98, 12288
s_nop 0
buffer_load_dwordx4 v210, s[44:47], s59 offen lds
s_add_u32 m0, s98, 13312
s_nop 0
buffer_load_dwordx4 v211, s[44:47], s59 offen lds
s_add_u32 m0, s98, 14336
s_nop 0
buffer_load_dwordx4 v212, s[44:47], s59 offen lds
s_add_u32 s59, s59, 10240
s_add_u32 m0, s98, 15360
s_nop 0
buffer_load_dwordx4 v208, s[44:47], s59 offen lds
s_add_u32 m0, s98, 16384
s_nop 0
buffer_load_dwordx4 v209, s[44:47], s59 offen lds
s_add_u32 m0, s98, 17408
s_nop 0
buffer_load_dwordx4 v210, s[44:47], s59 offen lds
s_add_u32 m0, s98, 18432
s_nop 0
buffer_load_dwordx4 v211, s[44:47], s59 offen lds
s_add_u32 m0, s98, 19456
s_nop 0
buffer_load_dwordx4 v212, s[44:47], s59 offen lds
v_mov_b32 v6, 0x3f803f80
v_mov_b32 v8, 0
v_mov_b32 v9, 0
v_mov_b32 v10, 0
v_mov_b32 v11, 0
v_lshlrev_b32 v5, 3, v2
s_waitcnt vmcnt(29)
v_dot2c_f32_bf16 v8, v32, v6
v_dot2c_f32_bf16 v9, v32, v32
v_dot2c_f32_bf16 v10, v33, v6
v_dot2c_f32_bf16 v11, v33, v33
v_dot2c_f32_bf16 v8, v34, v6
v_dot2c_f32_bf16 v9, v34, v34
v_dot2c_f32_bf16 v10, v35, v6
v_dot2c_f32_bf16 v11, v35, v35
s_waitcnt vmcnt(28)
v_dot2c_f32_bf16 v8, v36, v6
v_dot2c_f32_bf16 v9, v36, v36
v_dot2c_f32_bf16 v10, v37, v6
v_dot2c_f32_bf16 v11, v37, v37
v_dot2c_f32_bf16 v8, v38, v6
v_dot2c_f32_bf16 v9, v38, v38
v_dot2c_f32_bf16 v10, v39, v6
v_dot2c_f32_bf16 v11, v39, v39
s_waitcnt vmcnt(27)
v_dot2c_f32_bf16 v8, v40, v6
v_dot2c_f32_bf16 v9, v40, v40
v_dot2c_f32_bf16 v10, v41, v6
v_dot2c_f32_bf16 v11, v41, v41
v_dot2c_f32_bf16 v8, v42, v6
v_dot2c_f32_bf16 v9, v42, v42
v_dot2c_f32_bf16 v10, v43, v6
v_dot2c_f32_bf16 v11, v43, v43
s_waitcnt vmcnt(26)
v_dot2c_f32_bf16 v8, v44, v6
v_dot2c_f32_bf16 v9, v44, v44
v_dot2c_f32_bf16 v10, v45, v6
v_dot2c_f32_bf16 v11, v45, v45
v_dot2c_f32_bf16 v8, v46, v6
v_dot2c_f32_bf16 v9, v46, v46
v_dot2c_f32_bf16 v10, v47, v6
v_dot2c_f32_bf16 v11, v47, v47
s_waitcnt vmcnt(25)
v_dot2c_f32_bf16 v8, v48, v6
v_dot2c_f32_bf16 v9, v48, v48
v_dot2c_f32_bf16 v10, v49, v6
v_dot2c_f32_bf16 v11, v49, v49
v_dot2c_f32_bf16 v8, v50, v6
v_dot2c_f32_bf16 v9, v50, v50
v_dot2c_f32_bf16 v10, v51, v6
v_dot2c_f32_bf16 v11, v51, v51
s_waitcnt vmcnt(24)
v_dot2c_f32_bf16 v8, v52, v6
v_dot2c_f32_bf16 v9, v52, v52
v_dot2c_f32_bf16 v10, v53, v6
v_dot2c_f32_bf16 v11, v53, v53
v_dot2c_f32_bf16 v8, v54, v6
v_dot2c_f32_bf16 v9, v54, v54
v_dot2c_f32_bf16 v10, v55, v6
v_dot2c_f32_bf16 v11, v55, v55
s_waitcnt vmcnt(23)
v_dot2c_f32_bf16 v8, v56, v6
v_dot2c_f32_bf16 v9, v56, v56
v_dot2c_f32_bf16 v10, v57, v6
v_dot2c_f32_bf16 v11, v57, v57
v_dot2c_f32_bf16 v8, v58, v6
v_dot2c_f32_bf16 v9, v58, v58
v_dot2c_f32_bf16 v10, v59, v6
v_dot2c_f32_bf16 v11, v59, v59
s_waitcnt vmcnt(22)
v_dot2c_f32_bf16 v8, v60, v6
v_dot2c_f32_bf16 v9, v60, v60
v_dot2c_f32_bf16 v10, v61, v6
v_dot2c_f32_bf16 v11, v61, v61
v_dot2c_f32_bf16 v8, v62, v6
v_dot2c_f32_bf16 v9, v62, v62
v_dot2c_f32_bf16 v10, v63, v6
v_dot2c_f32_bf16 v11, v63, v63
s_waitcnt vmcnt(21)
v_dot2c_f32_bf16 v8, v64, v6
v_dot2c_f32_bf16 v9, v64, v64
v_dot2c_f32_bf16 v10, v65, v6
v_dot2c_f32_bf16 v11, v65, v65
v_dot2c_f32_bf16 v8, v66, v6
v_dot2c_f32_bf16 v9, v66, v66
v_dot2c_f32_bf16 v10, v67, v6
v_dot2c_f32_bf16 v11, v67, v67
s_waitcnt vmcnt(20)
v_dot2c_f32_bf16 v8, v68, v6
v_dot2c_f32_bf16 v9, v68, v68
v_dot2c_f32_bf16 v10, v69, v6
v_dot2c_f32_bf16 v11, v69, v69
v_dot2c_f32_bf16 v8, v70, v6
v_dot2c_f32_bf16 v9, v70, v70
v_dot2c_f32_bf16 v10, v71, v6
v_dot2c_f32_bf16 v11, v71, v71
s_nop 1
v_add_f32 v8, v8, v10
v_add_f32 v9, v9, v11
s_nop 0
v_add_f32_dpp v8, v8, v8 quad_perm:[1,0,3,2] row_mask:0xf bank_mask:0xf
v_add_f32_dpp v9, v9, v9 quad_perm:[1,0,3,2] row_mask:0xf bank_mask:0xf
s_nop 0
v_add_f32_dpp v8, v8, v8 quad_perm:[2,3,0,1] row_mask:0xf bank_mask:0xf
v_add_f32_dpp v9, v9, v9 quad_perm:[2,3,0,1] row_mask:0xf bank_mask:0xf
s_nop 0
v_add_f32_dpp v8, v8, v8 row_half_mirror row_mask:0xf bank_mask:0xf
v_add_f32_dpp v9, v9, v9 row_half_mirror row_mask:0xf bank_mask:0xf
s_lshl_b32 s55, s54, 6
s_add_u32 s55, s55, 16646144
s_mov_b32 exec_lo, 0x01010101
s_mov_b32 exec_hi, 0x01010101
buffer_store_dwordx2 v[8:9], v5, s[8:11], s55 offen sc1
s_mov_b64 exec, -1
s_waitcnt lgkmcnt(0)
s_mul_i32 s69, s68, 0x9e3779b1
s_add_u32 s69, s69, 0x7f4a7c15
s_lshl_b32 s6, s2, 7
s_add_u32 s6, s6, 16793600
s_waitcnt vmcnt(0)
s_barrier
s_cmp_lg_u32 s20, 0
s_cbranch_scc1 mn_nf3
s_mov_b64 exec, 1
v_mov_b32 v30, s69
buffer_store_dword v30, v255, s[8:11], s6 offen sc1
s_mov_b64 exec, -1
mn_nf3:
s_branch mn_jend
mn_jpf:
v_add_u32 v213, 0, v1
v_mul_u32_u24 v214, 205, v213
v_lshrrev_b32 v214, 13, v214
v_xor_b32 v213, v213, v214
v_mul_u32_u24 v214, 640, v214
v_lshl_add_u32 v208, v213, 4, v214
v_add_u32 v213, 64, v1
v_mul_u32_u24 v214, 205, v213
v_lshrrev_b32 v214, 13, v214
v_xor_b32 v213, v213, v214
v_mul_u32_u24 v214, 640, v214
v_lshl_add_u32 v209, v213, 4, v214
v_add_u32 v213, 128, v1
v_mul_u32_u24 v214, 205, v213
v_lshrrev_b32 v214, 13, v214
v_xor_b32 v213, v213, v214
v_mul_u32_u24 v214, 640, v214
v_lshl_add_u32 v210, v213, 4, v214
v_add_u32 v213, 192, v1
v_mul_u32_u24 v214, 205, v213
v_lshrrev_b32 v214, 13, v214
v_xor_b32 v213, v213, v214
v_mul_u32_u24 v214, 640, v214
v_lshl_add_u32 v211, v213, 4, v214
v_add_u32 v213, 256, v1
v_mul_u32_u24 v214, 205, v213
v_lshrrev_b32 v214, 13, v214
v_xor_b32 v213, v213, v214
v_mul_u32_u24 v214, 640, v214
v_lshl_add_u32 v212, v213, 4, v214
s_lshl_b32 s59, s21, 2
s_add_u32 s59, s59, s20
s_mul_i32 s59, s59, 40960
s_add_u32 s59, s59, 0
s_mul_i32 s98, s20, 20480
s_add_u32 s98, s98, 81920
s_add_u32 m0, s98, 0
s_nop 0
buffer_load_dwordx4 v208, s[44:47], s59 offen lds
s_add_u32 m0, s98, 1024
s_nop 0
buffer_load_dwordx4 v209, s[44:47], s59 offen lds
s_add_u32 m0, s98, 2048
s_nop 0
buffer_load_dwordx4 v210, s[44:47], s59 offen lds
s_add_u32 m0, s98, 3072
s_nop 0
buffer_load_dwordx4 v211, s[44:47], s59 offen lds
s_add_u32 m0, s98, 4096
s_nop 0
buffer_load_dwordx4 v212, s[44:47], s59 offen lds
s_add_u32 s59, s59, 10240
s_add_u32 m0, s98, 5120
s_nop 0
buffer_load_dwordx4 v208, s[44:47], s59 offen lds
s_add_u32 m0, s98, 6144
s_nop 0
buffer_load_dwordx4 v209, s[44:47], s59 offen lds
s_add_u32 m0, s98, 7168
s_nop 0
buffer_load_dwordx4 v210, s[44:47], s59 offen lds
s_add_u32 m0, s98, 8192
s_nop 0
buffer_load_dwordx4 v211, s[44:47], s59 offen lds
s_add_u32 m0, s98, 9216
s_nop 0
buffer_load_dwordx4 v212, s[44:47], s59 offen lds
s_add_u32 s59, s59, 10240
s_add_u32 m0, s98, 10240
s_nop 0
buffer_load_dwordx4 v208, s[44:47], s59 offen lds
s_add_u32 m0, s98, 11264
s_nop 0
buffer_load_dwordx4 v209, s[44:47], s59 offen lds
s_add_u32 m0, s98, 12288
s_nop 0
buffer_load_dwordx4 v210, s[44:47], s59 offen lds
s_add_u32 m0, s98, 13312
s_nop 0
buffer_load_dwordx4 v211, s[44:47], s59 offen lds
s_add_u32 m0, s98, 14336
s_nop 0
buffer_load_dwordx4 v212, s[44:47], s59 offen lds
s_add_u32 s59, s59, 10240
s_add_u32 m0, s98, 15360
s_nop 0
buffer_load_dwordx4 v208, s[44:47], s59 offen lds
s_add_u32 m0, s98, 16384
s_nop 0
buffer_load_dwordx4 v209, s[44:47], s59 offen lds
s_add_u32 m0, s98, 17408
s_nop 0
buffer_load_dwordx4 v210, s[44:47], s59 offen lds
s_add_u32 m0, s98, 18432
s_nop 0
buffer_load_dwordx4 v211, s[44:47], s59 offen lds
s_add_u32 m0, s98, 19456
s_nop 0
buffer_load_dwordx4 v212, s[44:47], s59 offen lds
s_waitcnt lgkmcnt(0)
s_mul_i32 s69, s68, 0x9e3779b1
s_add_u32 s69, s69, 0x7f4a7c15
mn_jend:
s_lshl_b32 s59, s21, 2
s_add_u32 s59, s59, s20
s_mul_i32 s59, s59, 40960
s_add_u32 s59, s59, 640
s_mul_i32 s98, s20, 20480
s_add_u32 s98, s98, 0
s_add_u32 m0, s98, 0
s_nop 0
buffer_load_dwordx4 v208, s[44:47], s59 offen lds
s_add_u32 m0, s98, 1024
s_nop 0
buffer_load_dwordx4 v209, s[44:47], s59 offen lds
s_add_u32 m0, s98, 2048
s_nop 0
buffer_load_dwordx4 v210, s[44:47], s59 offen lds
s_add_u32 m0, s98, 3072
s_nop 0
buffer_load_dwordx4 v211, s[44:47], s59 offen lds
s_add_u32 m0, s98, 4096
s_nop 0
buffer_load_dwordx4 v212, s[44:47], s59 offen lds
s_add_u32 s59, s59, 10240
s_add_u32 m0, s98, 5120
s_nop 0
buffer_load_dwordx4 v208, s[44:47], s59 offen lds
s_add_u32 m0, s98, 6144
s_nop 0
buffer_load_dwordx4 v209, s[44:47], s59 offen lds
s_add_u32 m0, s98, 7168
s_nop 0
buffer_load_dwordx4 v210, s[44:47], s59 offen lds
s_add_u32 m0, s98, 8192
s_nop 0
buffer_load_dwordx4 v211, s[44:47], s59 offen lds
s_add_u32 m0, s98, 9216
s_nop 0
buffer_load_dwordx4 v212, s[44:47], s59 offen lds
s_add_u32 s59, s59, 10240
s_add_u32 m0, s98, 10240
s_nop 0
buffer_load_dwordx4 v208, s[44:47], s59 offen lds
s_add_u32 m0, s98, 11264
s_nop 0
buffer_load_dwordx4 v209, s[44:47], s59 offen lds
s_add_u32 m0, s98, 12288
s_nop 0
buffer_load_dwordx4 v210, s[44:47], s59 offen lds
s_add_u32 m0, s98, 13312
s_nop 0
buffer_load_dwordx4 v211, s[44:47], s59 offen lds
s_add_u32 m0, s98, 14336
s_nop 0
buffer_load_dwordx4 v212, s[44:47], s59 offen lds
s_add_u32 s59, s59, 10240
s_add_u32 m0, s98, 15360
s_nop 0
buffer_load_dwordx4 v208, s[44:47], s59 offen lds
s_add_u32 m0, s98, 16384
s_nop 0
buffer_load_dwordx4 v209, s[44:47], s59 offen lds
s_add_u32 m0, s98, 17408
s_nop 0
buffer_load_dwordx4 v210, s[44:47], s59 offen lds
s_add_u32 m0, s98, 18432
s_nop 0
buffer_load_dwordx4 v211, s[44:47], s59 offen lds
s_add_u32 m0, s98, 19456
s_nop 0
buffer_load_dwordx4 v212, s[44:47], s59 offen lds
v_mov_b32 v216, -1
v_mov_b32 v220, 0
v_mov_b32 v217, -1
v_mov_b32 v221, 0
v_mov_b32 v218, -1
v_mov_b32 v222, 0
v_mov_b32 v219, -1
v_mov_b32 v223, 0
v_lshlrev_b32 v213, 4, v0
v_mov_b32 v214, 0x40000000
v_cmp_gt_u32 vcc, 224, v0
s_nop 1
v_cndmask_b32 v215, v214, v213, vcc
s_lshl_b32 s57, s22, 4
s_add_u32 s57, s57, s21
s_mul_i32 s57, s57, 3584
s_add_u32 s57, s57, 29229056
buffer_store_dwordx4 v[216:219], v215, s[8:11], s57 offen sc1
v_cmp_gt_u32 vcc, 4, v0
s_nop 1
v_cndmask_b32 v224, v214, v213, vcc
v_add_u32 v225, 13630976, v213
v_cmp_gt_u32 vcc, 64, v0
s_nop 1
v_cndmask_b32 v225, v214, v225, vcc
v_cmp_gt_u32 vcc, 32, v0
s_nop 1
v_cndmask_b32 v225, v225, v213, vcc
s_lshl_b32 s57, s21, 4
s_add_u32 s57, s57, s22
s_lshl_b32 s58, s57, 9
s_add_u32 s58, s58, 16515072
s_lshl_b32 s57, s57, 6
s_add_u32 s57, s57, 30277632
buffer_store_dwordx4 v[216:219], v225, s[8:11], s58 offen sc1
buffer_store_dwordx4 v[220:223], v224, s[8:11], s57 offen sc1
v_lshlrev_b32 v2, 4, v1
v_add_u32 v3, 4096, v2
v_and_b32 v4, 15, v1
v_lshrrev_b32 v5, 4, v1
v_and_b32 v6, 31, v1
v_lshrrev_b32 v7, 5, v1
s_lshr_b32 s3, s2, 3
s_mul_i32 s4, s3, 205
s_lshr_b32 s4, s4, 10
s_mul_i32 s5, s4, 5
s_sub_u32 s3, s3, s5
s_and_b32 s5, s2, 1
s_mul_i32 s5, s5, 5
s_add_u32 s25, s3, s5
s_bfe_u32 s5, s2, 0x20001
s_mul_i32 s5, s5, 6
s_add_u32 s26, s4, s5
v_and_b32 v28, 1, v4
v_cmp_eq_u32 vcc, 1, v28
v_mov_b32 v28, 0x3f80
v_mov_b32 v29, 0x3f800000
v_cndmask_b32 v28, v28, v29, vcc
v_lshrrev_b32 v29, 2, v4
v_cmp_eq_u32 vcc, v29, v5
s_nop 1
v_cndmask_b32 v28, 0, v28, vcc
v_bfe_u32 v29, v4, 1, 1
v_cmp_eq_u32 vcc, 0, v29
s_nop 1
v_cndmask_b32 v236, 0, v28, vcc
v_cmp_eq_u32 vcc, 1, v29
s_nop 1
v_cndmask_b32 v237, 0, v28, vcc
v_cmp_eq_u32 vcc, 2, v29
s_nop 1
v_cndmask_b32 v238, 0, v28, vcc
v_cmp_eq_u32 vcc, 3, v29
s_nop 1
v_cndmask_b32 v239, 0, v28, vcc
v_add_u32 v228, 61440, v2
v_add_u32 v229, 122880, v2
s_mul_i32 s3, s20, 1572864
s_lshl_b32 s4, s26, 7
s_add_u32 s48, s3, s4
s_lshl_b32 s4, s23, 7
s_add_u32 s49, s3, s4
s_mul_i32 s50, s20, 20480
s_add_u32 s50, s50, 40960
s_and_b32 s3, s20, 1
s_lshl_b32 s3, s3, 12
s_lshr_b32 s4, s20, 1
s_mul_i32 s4, s4, 122880
s_add_u32 s51, s3, s4
s_add_u32 s51, s51, 30720
s_sub_u32 s52, s51, s50
v_lshrrev_b32 v28, 3, v1
v_lshlrev_b32 v224, 12, v28
v_mul_u32_u24 v230, 3072, v28
v_and_b32 v29, 7, v1
v_bfe_u32 v28, v1, 4, 2
v_lshlrev_b32 v28, 1, v28
v_xor_b32 v28, v28, v29
v_lshl_add_u32 v224, v28, 4, v224
v_bfe_u32 v28, v1, 4, 1
v_lshlrev_b32 v28, 1, v28
v_xor_b32 v28, v28, v29
v_xor_b32 v29, 4, v28
v_lshl_add_u32 v231, v29, 4, v230
v_lshl_add_u32 v230, v28, 4, v230
v_add_u32 v225, 31744, v224
v_add_u32 v226, 63488, v224
v_add_u32 v227, 95232, v224
v_add_u32 v232, 47104, v230
v_add_u32 v233, 70656, v231
v_add_u32 v231, 23552, v231
v_lshrrev_b32 v28, 2, v1
v_lshlrev_b32 v28, 7, v28
v_and_b32 v29, 3, v1
v_lshl_add_u32 v28, v29, 3, v28
v_add_u32 v28, s50, v28
v_bfe_u32 v29, v1, 3, 2
v_lshlrev_b32 v31, 9, v5
v_add_u32 v31, v31, v28
s_add_u32 s3, s20, 0
s_and_b32 s3, s3, 3
v_xor_b32 v30, s3, v29
v_lshl_add_u32 v216, v30, 5, v28
v_add_u32 v220, s52, v216
v_xor_b32 v30, 0, v29
v_lshl_add_u32 v208, v30, 5, v31
v_add_u32 v212, s52, v208
s_add_u32 s3, s20, 1
s_and_b32 s3, s3, 3
v_xor_b32 v30, s3, v29
v_lshl_add_u32 v217, v30, 5, v28
v_add_u32 v221, s52, v217
v_xor_b32 v30, 1, v29
v_lshl_add_u32 v209, v30, 5, v31
v_add_u32 v213, s52, v209
s_add_u32 s3, s20, 2
s_and_b32 s3, s3, 3
v_xor_b32 v30, s3, v29
v_lshl_add_u32 v218, v30, 5, v28
v_add_u32 v222, s52, v218
v_xor_b32 v30, 2, v29
v_lshl_add_u32 v210, v30, 5, v31
v_add_u32 v214, s52, v210
s_add_u32 s3, s20, 3
s_and_b32 s3, s3, 3
v_xor_b32 v30, s3, v29
v_lshl_add_u32 v219, v30, 5, v28
v_add_u32 v223, s52, v219
v_xor_b32 v30, 3, v29
v_lshl_add_u32 v211, v30, 5, v31
v_add_u32 v215, s52, v211
v_mul_u32_u24 v8, 1280, v4
v_lshl_add_u32 v8, v5, 3, v8
s_lshl_b32 s3, s23, 2
s_add_u32 s3, s3, s20
s_mul_i32 s3, s3, 20480
s_mul_i32 s4, s24, 160
s_add_u32 s3, s3, s4
buffer_load_dwordx2 v[244:245], v8, s[44:47], s3 offen offset:0
buffer_load_dwordx2 v[246:247], v8, s[44:47], s3 offen offset:32
buffer_load_dwordx2 v[248:249], v8, s[44:47], s3 offen offset:64
buffer_load_dwordx2 v[250:251], v8, s[44:47], s3 offen offset:96
buffer_load_dwordx2 v[252:253], v8, s[44:47], s3 offen offset:128
v_mul_u32_u24 v32, 640, v6
s_mul_i32 s3, s20, 20480
v_add_u32 v32, s3, v32
v_and_b32 v33, 7, v6
v_add_u32 v34, 0, v7
v_xor_b32 v34, v34, v33
v_lshl_add_u32 v40, v34, 4, v32
v_add_u32 v36, 81920, v40
v_add_u32 v34, 2, v7
v_xor_b32 v34, v34, v33
v_lshl_add_u32 v41, v34, 4, v32
v_add_u32 v37, 81920, v41
v_add_u32 v34, 4, v7
v_xor_b32 v34, v34, v33
v_lshl_add_u32 v42, v34, 4, v32
v_add_u32 v38, 81920, v42
v_add_u32 v34, 6, v7
v_xor_b32 v34, v34, v33
v_lshl_add_u32 v43, v34, 4, v32
v_add_u32 v39, 81920, v43
s_cmp_lt_u32 s2, 80
s_cbranch_scc1 mn_nopf
s_sub_u32 s57, s2, 80
s_lshl_b32 s57, s57, 2
s_add_u32 s57, s57, s20
s_mul_i32 s57, s57, 9216
buffer_load_dwordx4 v[48:51], v2, s[60:63], s57 offen offset:0
buffer_load_dwordx4 v[56:59], v2, s[60:63], s57 offen offset:1024
buffer_load_dwordx4 v[64:67], v2, s[60:63], s57 offen offset:2048
buffer_load_dwordx4 v[72:75], v2, s[60:63], s57 offen offset:3072
s_add_u32 s57, s57, 4096
buffer_load_dwordx4 v[80:83], v2, s[60:63], s57 offen offset:0
buffer_load_dwordx4 v[88:91], v2, s[60:63], s57 offen offset:1024
buffer_load_dwordx4 v[96:99], v2, s[60:63], s57 offen offset:2048
buffer_load_dwordx4 v[104:107], v2, s[60:63], s57 offen offset:3072
s_add_u32 s57, s57, 4096
buffer_load_dwordx4 v[112:115], v2, s[60:63], s57 offen offset:0
s_waitcnt vmcnt(17)
s_branch mn_pfd
mn_nopf:
s_waitcnt vmcnt(8)
mn_pfd:
ds_read_b128 a[0:3], v36 offset:0
ds_read_b128 a[4:7], v37 offset:0
ds_read_b128 a[8:11], v38 offset:0
ds_read_b128 a[12:15], v39 offset:0
ds_read_b128 a[16:19], v36 offset:128
ds_read_b128 a[20:23], v37 offset:128
ds_read_b128 a[24:27], v38 offset:128
ds_read_b128 a[28:31], v39 offset:128
s_waitcnt lgkmcnt(6)
ds_read_b128 a[32:35], v36 offset:256
ds_read_b128 a[36:39], v37 offset:256
ds_read_b128 a[40:43], v38 offset:256
ds_read_b128 a[44:47], v39 offset:256
ds_read_b128 a[48:51], v36 offset:384
ds_read_b128 a[52:55], v37 offset:384
ds_read_b128 a[56:59], v38 offset:384
ds_read_b128 a[60:63], v39 offset:384
s_waitcnt lgkmcnt(6)
ds_read_b128 a[64:67], v36 offset:512
ds_read_b128 a[68:71], v37 offset:512
ds_read_b128 a[72:75], v38 offset:512
ds_read_b128 a[76:79], v39 offset:512
ds_read_b128 a[80:83], v40 offset:0
ds_read_b128 a[84:87], v41 offset:0
ds_read_b128 a[88:91], v42 offset:0
ds_read_b128 a[92:95], v43 offset:0
s_waitcnt lgkmcnt(6)
ds_read_b128 a[96:99], v40 offset:128
ds_read_b128 a[100:103], v41 offset:128
ds_read_b128 a[104:107], v42 offset:128
ds_read_b128 a[108:111], v43 offset:128
ds_read_b128 a[112:115], v40 offset:256
ds_read_b128 a[116:119], v41 offset:256
ds_read_b128 a[120:123], v42 offset:256
ds_read_b128 a[124:127], v43 offset:256
s_waitcnt lgkmcnt(6)
ds_read_b128 a[128:131], v40 offset:384
ds_read_b128 a[132:135], v41 offset:384
ds_read_b128 a[136:139], v42 offset:384
ds_read_b128 a[140:143], v43 offset:384
ds_read_b128 a[144:147], v40 offset:512
ds_read_b128 a[148:151], v41 offset:512
ds_read_b128 a[152:155], v42 offset:512
ds_read_b128 a[156:159], v43 offset:512
s_waitcnt lgkmcnt(6)
s_waitcnt lgkmcnt(0)
v_cmp_gt_u32 vcc, 5, v1
s_mul_i32 s3, s22, 5
v_add_u32 v28, s3, v1
s_lshl_b32 s3, s21, 2
s_add_u32 s3, s3, s20
s_add_u32 s3, s3, 130
v_mov_b32 v29, s3
v_cndmask_b32 v28, v29, v28, vcc
v_lshlrev_b32 v28, 7, v28
s_mov_b32 s6, 16793600
v_min_u32 v204, 49, v1
v_lshlrev_b32 v204, 7, v204
s_add_u32 s59, s29, 163840
s_mov_b64 exec, 0x3f
s_mov_b32 s5, 262144
mn_poll4:
buffer_load_dword v29, v28, s[8:11], s6 offen sc1
s_sub_u32 s5, s5, 1
s_cbranch_scc1 mn_pout5
s_waitcnt vmcnt(0)
v_cmpx_ne_u32 vcc, s69, v29
s_cbranch_execnz mn_poll4
mn_pout5:
s_waitcnt vmcnt(0)
s_mov_b64 exec, -1
s_nop 3
s_barrier
s_lshl_b32 s7, s21, 2
s_add_u32 s7, s7, s20
s_lshl_b32 s33, s7, 8
s_add_u32 s33, s33, s27
s_add_u32 s33, s33, 12451840
v_lshlrev_b32 v14, 3, v6
buffer_load_dwordx2 v[8:9], v14, s[8:11], s33 offen sc1
s_mul_i32 s31, s20, 3072
s_add_u32 s30, s29, s31
s_add_u32 m0, s31, 0
s_add_u32 s34, s30, 0
buffer_load_dwordx4 v2, s[8:11], s34 offen offset:0 sc1 lds
buffer_load_dwordx4 v2, s[8:11], s34 offen offset:1024 sc1 lds
buffer_load_dwordx4 v2, s[8:11], s34 offen offset:2048 sc1 lds
s_add_u32 m0, s31, 12288
s_add_u32 s34, s30, 12288
buffer_load_dwordx4 v2, s[8:11], s34 offen offset:0 sc1 lds
buffer_load_dwordx4 v2, s[8:11], s34 offen offset:1024 sc1 lds
buffer_load_dwordx4 v2, s[8:11], s34 offen offset:2048 sc1 lds
s_add_u32 m0, s31, 24576
s_add_u32 s34, s30, 24576
buffer_load_dwordx4 v2, s[8:11], s34 offen offset:0 sc1 lds
buffer_load_dwordx4 v2, s[8:11], s34 offen offset:1024 sc1 lds
buffer_load_dwordx4 v2, s[8:11], s34 offen offset:2048 sc1 lds
s_add_u32 m0, s31, 36864
s_add_u32 s34, s30, 36864
buffer_load_dwordx4 v2, s[8:11], s34 offen offset:0 sc1 lds
buffer_load_dwordx4 v2, s[8:11], s34 offen offset:1024 sc1 lds
buffer_load_dwordx4 v2, s[8:11], s34 offen offset:2048 sc1 lds
s_add_u32 m0, s31, 49152
s_add_u32 s34, s30, 49152
buffer_load_dwordx4 v2, s[8:11], s34 offen offset:0 sc1 lds
buffer_load_dwordx4 v2, s[8:11], s34 offen offset:1024 sc1 lds
buffer_load_dwordx4 v2, s[8:11], s34 offen offset:2048 sc1 lds
s_add_u32 m0, s31, 61440
s_add_u32 s34, s30, 61440
buffer_load_dwordx4 v2, s[8:11], s34 offen offset:0 sc1 lds
buffer_load_dwordx4 v2, s[8:11], s34 offen offset:1024 sc1 lds
buffer_load_dwordx4 v2, s[8:11], s34 offen offset:2048 sc1 lds
s_add_u32 m0, s31, 73728
s_add_u32 s34, s30, 73728
buffer_load_dwordx4 v2, s[8:11], s34 offen offset:0 sc1 lds
buffer_load_dwordx4 v2, s[8:11], s34 offen offset:1024 sc1 lds
buffer_load_dwordx4 v2, s[8:11], s34 offen offset:2048 sc1 lds
s_waitcnt vmcnt(12)
s_barrier
ds_read_b128 v[96:99], v2 offset:0
ds_read_b128 v[100:103], v2 offset:1024
ds_read_b128 v[104:107], v2 offset:2048
ds_read_b128 v[108:111], v2 offset:3072
ds_read_b128 v[112:115], v2 offset:4096
ds_read_b128 v[116:119], v2 offset:5120
s_waitcnt lgkmcnt(3)
v_mfma_f32_32x32x16_bf16 v[32:47], v[96:99], a[0:3], 0
ds_read_b128 v[120:123], v2 offset:6144
s_add_u32 m0, s31, 86016
s_add_u32 s34, s30, 86016
buffer_load_dwordx4 v2, s[8:11], s34 offen offset:0 sc1 lds
v_mfma_f32_32x32x16_bf16 v[48:63], v[100:103], a[0:3], 0
ds_read_b128 v[124:127], v2 offset:7168
buffer_load_dwordx4 v2, s[8:11], s34 offen offset:1024 sc1 lds
v_mfma_f32_32x32x16_bf16 v[64:79], v[104:107], a[0:3], 0
ds_read_b128 v[128:131], v2 offset:8192
s_waitcnt lgkmcnt(3)
v_mfma_f32_32x32x16_bf16 v[32:47], v[108:111], a[4:7], v[32:47]
ds_read_b128 v[132:135], v2 offset:9216
buffer_load_dwordx4 v2, s[8:11], s34 offen offset:2048 sc1 lds
v_mfma_f32_32x32x16_bf16 v[48:63], v[112:115], a[4:7], v[48:63]
ds_read_b128 v[136:139], v2 offset:10240
v_mfma_f32_32x32x16_bf16 v[64:79], v[116:119], a[4:7], v[64:79]
ds_read_b128 v[140:143], v2 offset:11264
s_waitcnt lgkmcnt(3)
v_mfma_f32_32x32x16_bf16 v[32:47], v[120:123], a[8:11], v[32:47]
ds_read_b128 v[144:147], v2 offset:12288
s_mul_i32 s31, s20, 3072
s_add_u32 s30, s29, s31
s_add_u32 m0, s31, 98304
s_add_u32 s34, s30, 98304
buffer_load_dwordx4 v2, s[8:11], s34 offen offset:0 sc1 lds
v_mfma_f32_32x32x16_bf16 v[48:63], v[124:127], a[8:11], v[48:63]
ds_read_b128 v[148:151], v2 offset:13312
buffer_load_dwordx4 v2, s[8:11], s34 offen offset:1024 sc1 lds
v_mul_f32 v8, 0x3acccccd, v8
v_mul_f32 v9, 0x3acccccd, v9
v_mfma_f32_32x32x16_bf16 v[64:79], v[128:131], a[8:11], v[64:79]
ds_read_b128 v[152:155], v2 offset:14336
s_waitcnt lgkmcnt(3)
v_mfma_f32_32x32x16_bf16 v[32:47], v[132:135], a[12:15], v[32:47]
ds_read_b128 v[156:159], v2 offset:15360
buffer_load_dwordx4 v2, s[8:11], s34 offen offset:2048 sc1 lds
v_mfma_f32_32x32x16_bf16 v[48:63], v[136:139], a[12:15], v[48:63]
ds_read_b128 v[160:163], v2 offset:16384
v_fma_f32 v9, -v8, v8, v9
v_max_f32 v9, 0, v9
v_mfma_f32_32x32x16_bf16 v[64:79], v[140:143], a[12:15], v[64:79]
ds_read_b128 v[164:167], v2 offset:17408
s_waitcnt lgkmcnt(3)
v_mfma_f32_32x32x16_bf16 v[32:47], v[144:147], a[16:19], v[32:47]
ds_read_b128 v[96:99], v2 offset:18432
s_add_u32 m0, s31, 110592
s_add_u32 s34, s30, 110592
buffer_load_dwordx4 v2, s[8:11], s34 offen offset:0 sc1 lds
v_mfma_f32_32x32x16_bf16 v[48:63], v[148:151], a[16:19], v[48:63]
ds_read_b128 v[100:103], v2 offset:19456
buffer_load_dwordx4 v2, s[8:11], s34 offen offset:1024 sc1 lds
v_add_f32 v9, 0x3727c5ac, v9
v_rsq_f32 v10, v9
v_mfma_f32_32x32x16_bf16 v[64:79], v[152:155], a[16:19], v[64:79]
ds_read_b128 v[104:107], v2 offset:20480
s_waitcnt lgkmcnt(3)
v_mfma_f32_32x32x16_bf16 v[32:47], v[156:159], a[20:23], v[32:47]
ds_read_b128 v[108:111], v2 offset:21504
buffer_load_dwordx4 v2, s[8:11], s34 offen offset:2048 sc1 lds
v_mfma_f32_32x32x16_bf16 v[48:63], v[160:163], a[20:23], v[48:63]
ds_read_b128 v[112:115], v2 offset:22528
v_sub_f32 v192, 0, v8
v_cvt_pk_bf16_f32 v193, v192, v192
v_mfma_f32_32x32x16_bf16 v[64:79], v[164:167], a[20:23], v[64:79]
ds_read_b128 v[116:119], v2 offset:23552
s_waitcnt lgkmcnt(3)
v_mfma_f32_32x32x16_bf16 v[32:47], v[96:99], a[24:27], v[32:47]
ds_read_b128 v[120:123], v2 offset:24576
s_mul_i32 s31, s20, 10240
s_add_u32 s30, s29, s31
s_add_u32 m0, s31, 122880
s_add_u32 s34, s30, 122880
buffer_load_dwordx4 v2, s[8:11], s34 offen offset:0 sc1 lds
v_mfma_f32_32x32x16_bf16 v[48:63], v[100:103], a[24:27], v[48:63]
ds_read_b128 v[124:127], v2 offset:25600
buffer_load_dwordx4 v2, s[8:11], s34 offen offset:1024 sc1 lds
v_lshlrev_b32 v194, 16, v193
v_sub_f32 v194, v192, v194
v_mfma_f32_32x32x16_bf16 v[64:79], v[104:107], a[24:27], v[64:79]
ds_read_b128 v[128:131], v2 offset:26624
s_waitcnt lgkmcnt(3)
v_mfma_f32_32x32x16_bf16 v[32:47], v[108:111], a[28:31], v[32:47]
ds_read_b128 v[132:135], v2 offset:27648
buffer_load_dwordx4 v2, s[8:11], s34 offen offset:2048 sc1 lds
v_mfma_f32_32x32x16_bf16 v[48:63], v[112:115], a[28:31], v[48:63]
ds_read_b128 v[136:139], v2 offset:28672
v_cvt_pk_bf16_f32 v194, v194, v194
v_mov_b32 v195, 0xffff
v_mfma_f32_32x32x16_bf16 v[64:79], v[116:119], a[28:31], v[64:79]
ds_read_b128 v[140:143], v2 offset:29696
s_waitcnt lgkmcnt(3)
v_mfma_f32_32x32x16_bf16 v[32:47], v[120:123], a[32:35], v[32:47]
ds_read_b128 v[144:147], v2 offset:30720
buffer_load_dwordx4 v2, s[8:11], s34 offen offset:3072 sc1 lds
v_mfma_f32_32x32x16_bf16 v[48:63], v[124:127], a[32:35], v[48:63]
ds_read_b128 v[148:151], v2 offset:31744
s_add_u32 m0, s31, 126976
s_add_u32 s34, s30, 126976
buffer_load_dwordx4 v2, s[8:11], s34 offen offset:0 sc1 lds
v_bfi_b32 v196, v195, v194, v193
v_bfi_b32 v197, v195, v193, v194
v_mfma_f32_32x32x16_bf16 v[64:79], v[128:131], a[32:35], v[64:79]
ds_read_b128 v[152:155], v2 offset:32768
s_waitcnt vmcnt(17)
s_barrier
s_waitcnt lgkmcnt(3)
v_mfma_f32_32x32x16_bf16 v[32:47], v[132:135], a[36:39], v[32:47]
ds_read_b128 v[156:159], v2 offset:33792
buffer_load_dwordx4 v2, s[8:11], s34 offen offset:1024 sc1 lds
v_mfma_f32_32x32x16_bf16 v[48:63], v[136:139], a[36:39], v[48:63]
ds_read_b128 v[160:163], v2 offset:34816
v_and_b32 v198, v195, v194
v_cmp_eq_u32 vcc, 1, v7
v_mfma_f32_32x32x16_bf16 v[64:79], v[140:143], a[36:39], v[64:79]
ds_read_b128 v[164:167], v2 offset:35840
s_waitcnt lgkmcnt(3)
v_mfma_f32_32x32x16_bf16 v[32:47], v[144:147], a[40:43], v[32:47]
ds_read_b128 v[96:99], v2 offset:36864
buffer_load_dwordx4 v2, s[8:11], s34 offen offset:2048 sc1 lds
v_mfma_f32_32x32x16_bf16 v[48:63], v[148:151], a[40:43], v[48:63]
ds_read_b128 v[100:103], v2 offset:37888
buffer_load_dwordx4 v2, s[8:11], s34 offen offset:3072 sc1 lds
v_cndmask_b32 v12, v193, v196, vcc
v_cndmask_b32 v13, v196, v197, vcc
v_mfma_f32_32x32x16_bf16 v[64:79], v[152:155], a[40:43], v[64:79]
ds_read_b128 v[104:107], v2 offset:38912
s_waitcnt lgkmcnt(3)
v_mfma_f32_32x32x16_bf16 v[32:47], v[156:159], a[44:47], v[32:47]
ds_read_b128 v[108:111], v2 offset:39936
s_add_u32 m0, s31, 131072
s_add_u32 s34, s30, 131072
buffer_load_dwordx4 v2, s[8:11], s34 offen offset:0 sc1 lds
v_mfma_f32_32x32x16_bf16 v[48:63], v[160:163], a[44:47], v[48:63]
ds_read_b128 v[112:115], v2 offset:40960
v_cndmask_b32 v14, v197, v193, vcc
v_cndmask_b32 v15, v193, v198, vcc
v_mfma_f32_32x32x16_bf16 v[64:79], v[164:167], a[44:47], v[64:79]
ds_read_b128 v[116:119], v2 offset:41984
s_waitcnt lgkmcnt(3)
v_mfma_f32_32x32x16_bf16 v[32:47], v[96:99], a[48:51], v[32:47]
ds_read_b128 v[120:123], v2 offset:43008
buffer_load_dwordx4 v2, s[8:11], s34 offen offset:1024 sc1 lds
v_mfma_f32_32x32x16_bf16 v[48:63], v[100:103], a[48:51], v[48:63]
ds_read_b128 v[124:127], v2 offset:44032
buffer_load_dwordx4 v[16:19], v2, s[8:11], s59 offen offset:0 sc1
v_mul_f32 v8, 0x3fb8aa3b, v10
v_mfma_f32_32x32x16_bf16 v[64:79], v[104:107], a[48:51], v[64:79]
ds_read_b128 v[128:131], v2 offset:45056
s_waitcnt lgkmcnt(3)
v_mfma_f32_32x32x16_bf16 v[32:47], v[108:111], a[52:55], v[32:47]
ds_read_b128 v[132:135], v2 offset:46080
buffer_load_dwordx4 v[20:23], v2, s[8:11], s59 offen offset:1024 sc1
v_mfma_f32_32x32x16_bf16 v[48:63], v[112:115], a[52:55], v[48:63]
ds_read_b128 v[136:139], v2 offset:47104
v_mfma_f32_32x32x16_bf16 v[64:79], v[116:119], a[52:55], v[64:79]
ds_read_b128 v[140:143], v2 offset:48128
s_waitcnt lgkmcnt(3)
v_mfma_f32_32x32x16_bf16 v[32:47], v[120:123], a[56:59], v[32:47]
ds_read_b128 v[144:147], v2 offset:49152
buffer_load_dwordx4 v[24:27], v2, s[8:11], s59 offen offset:2048 sc1
v_mfma_f32_32x32x16_bf16 v[48:63], v[124:127], a[56:59], v[48:63]
ds_read_b128 v[148:151], v2 offset:50176
buffer_load_dwordx4 v[28:31], v2, s[8:11], s59 offen offset:3072 sc1
v_mfma_f32_32x32x16_bf16 v[64:79], v[128:131], a[56:59], v[64:79]
ds_read_b128 v[152:155], v2 offset:51200
s_waitcnt lgkmcnt(3)
v_mfma_f32_32x32x16_bf16 v[32:47], v[132:135], a[60:63], v[32:47]
ds_read_b128 v[156:159], v2 offset:52224
s_mov_b32 s6, 16803840
buffer_load_dword v205, v204, s[8:11], s6 offen sc1
v_mfma_f32_32x32x16_bf16 v[48:63], v[136:139], a[60:63], v[48:63]
ds_read_b128 v[160:163], v2 offset:53248
v_mfma_f32_32x32x16_bf16 v[64:79], v[140:143], a[60:63], v[64:79]
ds_read_b128 v[164:167], v2 offset:54272
s_waitcnt lgkmcnt(3)
v_mfma_f32_32x32x16_bf16 v[32:47], v[144:147], a[64:67], v[32:47]
ds_read_b128 v[96:99], v2 offset:55296
s_lshl_b32 s57, s2, 2
s_add_u32 s57, s57, s20
s_mul_i32 s57, s57, 6144
buffer_load_dwordx4 a[160:163], v2, s[64:67], s57 offen offset:0
v_mfma_f32_32x32x16_bf16 v[48:63], v[148:151], a[64:67], v[48:63]
ds_read_b128 v[100:103], v2 offset:56320
buffer_load_dwordx4 a[160:163], v2, s[64:67], s57 offen offset:1024
v_mfma_f32_32x32x16_bf16 v[64:79], v[152:155], a[64:67], v[64:79]
ds_read_b128 v[104:107], v2 offset:57344
s_waitcnt lgkmcnt(3)
v_mfma_f32_32x32x16_bf16 v[32:47], v[156:159], a[68:71], v[32:47]
ds_read_b128 v[108:111], v2 offset:58368
buffer_load_dwordx4 a[160:163], v2, s[64:67], s57 offen offset:2048
v_mfma_f32_32x32x16_bf16 v[48:63], v[160:163], a[68:71], v[48:63]
ds_read_b128 v[112:115], v2 offset:59392
v_mfma_f32_32x32x16_bf16 v[64:79], v[164:167], a[68:71], v[64:79]
ds_read_b128 v[116:119], v2 offset:60416
s_waitcnt lgkmcnt(3)
v_mfma_f32_32x32x16_bf16 v[32:47], v[96:99], a[72:75], v[32:47]
ds_read_b128 v[120:123], v228 offset:0
buffer_load_dwordx4 a[160:163], v2, s[64:67], s57 offen offset:3072
v_mfma_f32_32x32x16_bf16 v[48:63], v[100:103], a[72:75], v[48:63]
ds_read_b128 v[124:127], v228 offset:1024
s_add_u32 s57, s57, 4096
buffer_load_dwordx4 a[160:163], v2, s[64:67], s57 offen offset:0
v_mfma_f32_32x32x16_bf16 v[64:79], v[104:107], a[72:75], v[64:79]
ds_read_b128 v[128:131], v228 offset:2048
s_waitcnt lgkmcnt(3)
v_mfma_f32_32x32x16_bf16 v[32:47], v[108:111], a[76:79], v[32:47]
ds_read_b128 v[132:135], v228 offset:3072
buffer_load_dwordx4 a[160:163], v2, s[64:67], s57 offen offset:1024
v_mfma_f32_32x32x16_bf16 v[48:63], v[112:115], a[76:79], v[48:63]
ds_read_b128 v[136:139], v228 offset:4096
v_mfma_f32_32x32x16_bf16 v[64:79], v[116:119], a[76:79], v[64:79]
ds_read_b128 v[140:143], v228 offset:5120
s_waitcnt lgkmcnt(3)
v_mfma_f32_32x32x16_bf16 v[32:47], v[120:123], a[80:83], v[32:47]
ds_read_b128 v[144:147], v228 offset:6144
v_mfma_f32_32x32x16_bf16 v[48:63], v[124:127], a[80:83], v[48:63]
ds_read_b128 v[148:151], v228 offset:7168
v_mfma_f32_32x32x16_bf16 v[64:79], v[128:131], a[80:83], v[64:79]
ds_read_b128 v[152:155], v228 offset:8192
s_waitcnt vmcnt(21)
s_barrier
s_waitcnt lgkmcnt(3)
v_mfma_f32_32x32x16_bf16 v[32:47], v[132:135], a[84:87], v[32:47]
ds_read_b128 v[156:159], v228 offset:9216
v_mfma_f32_32x32x16_bf16 v[48:63], v[136:139], a[84:87], v[48:63]
ds_read_b128 v[160:163], v228 offset:10240
v_mfma_f32_32x32x16_bf16 v[64:79], v[140:143], a[84:87], v[64:79]
ds_read_b128 v[164:167], v228 offset:11264
s_waitcnt lgkmcnt(3)
v_mfma_f32_32x32x16_bf16 v[32:47], v[144:147], a[88:91], v[32:47]
ds_read_b128 v[96:99], v228 offset:12288
v_mfma_f32_32x32x16_bf16 v[48:63], v[148:151], a[88:91], v[48:63]
ds_read_b128 v[100:103], v228 offset:13312
v_mfma_f32_32x32x16_bf16 v[64:79], v[152:155], a[88:91], v[64:79]
ds_read_b128 v[104:107], v228 offset:15360
s_waitcnt lgkmcnt(3)
v_mfma_f32_32x32x16_bf16 v[32:47], v[156:159], a[92:95], v[32:47]
ds_read_b128 v[108:111], v228 offset:16384
v_mfma_f32_32x32x16_bf16 v[48:63], v[160:163], a[92:95], v[48:63]
ds_read_b128 v[112:115], v228 offset:18432
v_mfma_f32_32x32x16_bf16 v[64:79], v[164:167], a[92:95], v[64:79]
ds_read_b128 v[116:119], v228 offset:19456
s_waitcnt lgkmcnt(4)
v_mfma_f32_32x32x16_bf16 v[32:47], v[96:99], a[96:99], v[32:47]
ds_read_b128 v[120:123], v228 offset:21504
v_mfma_f32_32x32x16_bf16 v[48:63], v[100:103], a[96:99], v[48:63]
ds_read_b128 v[124:127], v228 offset:22528
s_waitcnt lgkmcnt(4)
v_mfma_f32_32x32x16_bf16 v[32:47], v[104:107], a[100:103], v[32:47]
ds_read_b128 v[128:131], v228 offset:24576
v_mfma_f32_32x32x16_bf16 v[48:63], v[108:111], a[100:103], v[48:63]
ds_read_b128 v[132:135], v228 offset:25600
s_waitcnt lgkmcnt(4)
v_mfma_f32_32x32x16_bf16 v[32:47], v[112:115], a[104:107], v[32:47]
ds_read_b128 v[136:139], v228 offset:27648
v_mfma_f32_32x32x16_bf16 v[48:63], v[116:119], a[104:107], v[48:63]
ds_read_b128 v[140:143], v228 offset:28672
s_waitcnt vmcnt(6)
v_cmp_ne_u32 vcc, s69, v205
s_cbranch_vccz mn_wook
s_mov_b64 exec, -1
s_mov_b32 s5, 262144
mn_poll6:
buffer_load_dword v205, v204, s[8:11], s6 offen sc1
s_sub_u32 s5, s5, 1
s_cbranch_scc1 mn_pout7
s_waitcnt vmcnt(0)
v_cmpx_ne_u32 vcc, s69, v205
s_cbranch_execnz mn_poll6
mn_pout7:
s_waitcnt vmcnt(0)
s_mov_b64 exec, -1
s_nop 3
mn_wook:
s_waitcnt lgkmcnt(4)
v_mfma_f32_32x32x16_bf16 v[32:47], v[120:123], a[108:111], v[32:47]
ds_read_b128 v[144:147], v228 offset:30720
v_mfma_f32_32x32x16_bf16 v[48:63], v[124:127], a[108:111], v[48:63]
ds_read_b128 v[148:151], v228 offset:31744
s_waitcnt lgkmcnt(4)
v_mfma_f32_32x32x16_bf16 v[32:47], v[128:131], a[112:115], v[32:47]
ds_read_b128 v[152:155], v228 offset:33792
s_mul_i32 s3, s24, 102400
s_mul_i32 s4, s20, 5120
s_add_u32 s3, s3, s4
s_add_u32 s54, s3, 3145728
s_add_u32 s55, s54, 20480
s_add_u32 s56, s54, 40960
s_add_u32 s57, s54, 61440
s_add_u32 s58, s54, 81920
buffer_load_dwordx4 a[160:163], v2, s[8:11], s54 offen offset:0 sc1
v_mfma_f32_32x32x16_bf16 v[48:63], v[132:135], a[112:115], v[48:63]
ds_read_b128 v[156:159], v228 offset:34816
s_waitcnt lgkmcnt(4)
v_mfma_f32_32x32x16_bf16 v[32:47], v[136:139], a[116:119], v[32:47]
ds_read_b128 v[160:163], v228 offset:36864
buffer_load_dwordx4 a[164:167], v2, s[8:11], s55 offen offset:0 sc1
v_mfma_f32_32x32x16_bf16 v[48:63], v[140:143], a[116:119], v[48:63]
ds_read_b128 v[164:167], v228 offset:37888
s_waitcnt lgkmcnt(4)
v_mfma_f32_32x32x16_bf16 v[32:47], v[144:147], a[120:123], v[32:47]
ds_read_b128 v[96:99], v228 offset:39936
buffer_load_dwordx4 a[168:171], v2, s[8:11], s56 offen offset:0 sc1
v_mfma_f32_32x32x16_bf16 v[48:63], v[148:151], a[120:123], v[48:63]
ds_read_b128 v[100:103], v228 offset:40960
s_waitcnt lgkmcnt(4)
v_mfma_f32_32x32x16_bf16 v[32:47], v[152:155], a[124:127], v[32:47]
ds_read_b128 v[104:107], v228 offset:43008
buffer_load_dwordx4 a[172:175], v2, s[8:11], s57 offen offset:0 sc1
v_mfma_f32_32x32x16_bf16 v[48:63], v[156:159], a[124:127], v[48:63]
ds_read_b128 v[108:111], v228 offset:44032
s_waitcnt lgkmcnt(4)
v_mfma_f32_32x32x16_bf16 v[32:47], v[160:163], a[128:131], v[32:47]
ds_read_b128 v[112:115], v228 offset:46080
buffer_load_dwordx4 a[176:179], v2, s[8:11], s58 offen offset:0 sc1
v_mfma_f32_32x32x16_bf16 v[48:63], v[164:167], a[128:131], v[48:63]
ds_read_b128 v[116:119], v228 offset:47104
s_waitcnt lgkmcnt(4)
v_mfma_f32_32x32x16_bf16 v[32:47], v[96:99], a[132:135], v[32:47]
ds_read_b128 v[120:123], v228 offset:49152
buffer_load_dwordx4 a[180:183], v2, s[8:11], s54 offen offset:1024 sc1
v_mfma_f32_32x32x16_bf16 v[48:63], v[100:103], a[132:135], v[48:63]
ds_read_b128 v[124:127], v228 offset:50176
s_waitcnt lgkmcnt(4)
v_mfma_f32_32x32x16_bf16 v[32:47], v[104:107], a[136:139], v[32:47]
ds_read_b128 v[128:131], v228 offset:52224
buffer_load_dwordx4 a[184:187], v2, s[8:11], s55 offen offset:1024 sc1
v_mfma_f32_32x32x16_bf16 v[48:63], v[108:111], a[136:139], v[48:63]
ds_read_b128 v[132:135], v228 offset:53248
s_waitcnt lgkmcnt(4)
v_mfma_f32_32x32x16_bf16 v[32:47], v[112:115], a[140:143], v[32:47]
ds_read_b128 v[136:139], v228 offset:55296
buffer_load_dwordx4 a[188:191], v2, s[8:11], s56 offen offset:1024 sc1
v_mfma_f32_32x32x16_bf16 v[48:63], v[116:119], a[140:143], v[48:63]
ds_read_b128 v[140:143], v228 offset:56320
s_waitcnt lgkmcnt(4)
v_mfma_f32_32x32x16_bf16 v[32:47], v[120:123], a[144:147], v[32:47]
ds_read_b128 v[144:147], v228 offset:58368
buffer_load_dwordx4 a[192:195], v2, s[8:11], s57 offen offset:1024 sc1
v_mfma_f32_32x32x16_bf16 v[48:63], v[124:127], a[144:147], v[48:63]
ds_read_b128 v[148:151], v228 offset:59392
s_waitcnt lgkmcnt(4)
v_mfma_f32_32x32x16_bf16 v[32:47], v[128:131], a[148:151], v[32:47]
ds_read_b128 v[168:171], v228 offset:14336
buffer_load_dwordx4 a[196:199], v2, s[8:11], s58 offen offset:1024 sc1
v_mfma_f32_32x32x16_bf16 v[48:63], v[132:135], a[148:151], v[48:63]
ds_read_b128 v[172:175], v228 offset:17408
s_waitcnt lgkmcnt(4)
v_mfma_f32_32x32x16_bf16 v[32:47], v[136:139], a[152:155], v[32:47]
ds_read_b128 v[176:179], v228 offset:20480
buffer_load_dwordx4 a[200:203], v2, s[8:11], s54 offen offset:2048 sc1
v_mfma_f32_32x32x16_bf16 v[48:63], v[140:143], a[152:155], v[48:63]
ds_read_b128 v[180:183], v228 offset:23552
s_waitcnt lgkmcnt(4)
v_mfma_f32_32x32x16_bf16 v[32:47], v[144:147], a[156:159], v[32:47]
ds_read_b128 v[184:187], v228 offset:26624
buffer_load_dwordx4 a[204:207], v2, s[8:11], s55 offen offset:2048 sc1
v_mfma_f32_32x32x16_bf16 v[48:63], v[148:151], a[156:159], v[48:63]
v_mfma_f32_32x32x16_bf16 v[32:47], v[16:19], v[12:15], v[32:47]
v_mfma_f32_32x32x16_bf16 v[48:63], v[20:23], v[12:15], v[48:63]
s_waitcnt lgkmcnt(4)
v_mfma_f32_32x32x16_bf16 v[64:79], v[168:171], a[96:99], v[64:79]
ds_read_b128 v[188:191], v228 offset:29696
s_waitcnt lgkmcnt(4)
v_mfma_f32_32x32x16_bf16 v[64:79], v[172:175], a[100:103], v[64:79]
ds_read_b128 v[168:171], v228 offset:32768
s_lshl_b32 s3, s20, 5
v_lshl_add_u32 v200, v7, 7, v6
v_add_u32 v200, s3, v200
v_mul_u32_u24 v200, 160, v200
s_lshr_b32 s36, s20, 1
s_and_b32 s37, s20, 1
v_lshrrev_b32 v201, 2, v1
v_mul_u32_u24 v201, 160, v201
v_and_b32 v202, 3, v1
v_lshl_add_u32 v201, v202, 3, v201
s_mul_i32 s3, s36, 20480
s_lshl_b32 s4, s37, 5
s_add_u32 s4, s4, 64
v_add_u32 v201, s3, v201
v_add_u32 v202, s4, v201
v_max3_f32 v128, v32, v33, v34
buffer_load_dwordx4 a[208:211], v2, s[8:11], s56 offen offset:2048 sc1
s_waitcnt lgkmcnt(4)
v_mfma_f32_32x32x16_bf16 v[64:79], v[176:179], a[104:107], v[64:79]
ds_read_b128 v[172:175], v228 offset:35840
v_min3_f32 v136, v32, v33, v34
v_max3_f32 v129, v35, v36, v37
v_min3_f32 v137, v35, v36, v37
v_max3_f32 v130, v38, v39, v40
v_min3_f32 v138, v38, v39, v40
v_max3_f32 v131, v41, v42, v43
v_min3_f32 v139, v41, v42, v43
v_max3_f32 v132, v44, v45, v46
v_min3_f32 v140, v44, v45, v46
s_waitcnt lgkmcnt(4)
v_mfma_f32_32x32x16_bf16 v[64:79], v[180:183], a[108:111], v[64:79]
ds_read_b128 v[176:179], v228 offset:38912
v_max3_f32 v133, v47, v48, v49
buffer_load_dwordx4 a[212:215], v2, s[8:11], s57 offen offset:2048 sc1
v_min3_f32 v141, v47, v48, v49
v_max3_f32 v128, v128, v50, v51
v_min3_f32 v136, v136, v50, v51
v_max3_f32 v129, v129, v130, v131
v_min3_f32 v137, v137, v138, v139
v_max3_f32 v128, v128, v132, v133
v_min3_f32 v136, v136, v140, v141
v_max_f32 v128, v128, v129
s_waitcnt lgkmcnt(4)
v_mfma_f32_32x32x16_bf16 v[64:79], v[184:187], a[112:115], v[64:79]
ds_read_b128 v[180:183], v228 offset:41984
v_min_f32 v136, v136, v137
v_mul_f32 v194, v128, -v8
buffer_load_dwordx4 a[216:219], v2, s[8:11], s58 offen offset:2048 sc1
v_mul_f32 v196, v136, v8
v_pk_fma_f32 v[128:129], v[32:33], v[8:9], v[194:195] op_sel_hi:[1,0,0]
v_pk_fma_f32 v[148:149], v[32:33], v[8:9], v[196:197] op_sel_hi:[1,0,0] neg_lo:[1,0,0] neg_hi:[1,0,0]
v_pk_fma_f32 v[130:131], v[34:35], v[8:9], v[194:195] op_sel_hi:[1,0,0]
v_pk_fma_f32 v[150:151], v[34:35], v[8:9], v[196:197] op_sel_hi:[1,0,0] neg_lo:[1,0,0] neg_hi:[1,0,0]
v_exp_f32 v128, v128
v_exp_f32 v129, v129
s_waitcnt lgkmcnt(4)
v_mfma_f32_32x32x16_bf16 v[64:79], v[188:191], a[116:119], v[64:79]
ds_read_b128 v[184:187], v228 offset:45056
v_pk_fma_f32 v[132:133], v[36:37], v[8:9], v[194:195] op_sel_hi:[1,0,0]
v_exp_f32 v148, v148
v_exp_f32 v149, v149
v_pk_fma_f32 v[152:153], v[36:37], v[8:9], v[196:197] op_sel_hi:[1,0,0] neg_lo:[1,0,0] neg_hi:[1,0,0]
buffer_load_dwordx4 a[220:223], v2, s[8:11], s54 offen offset:3072 sc1
v_exp_f32 v130, v130
v_exp_f32 v131, v131
v_pk_fma_f32 v[134:135], v[38:39], v[8:9], v[194:195] op_sel_hi:[1,0,0]
v_exp_f32 v150, v150
v_exp_f32 v151, v151
s_waitcnt lgkmcnt(4)
v_mfma_f32_32x32x16_bf16 v[64:79], v[168:171], a[120:123], v[64:79]
ds_read_b128 v[188:191], v228 offset:48128
v_pk_fma_f32 v[154:155], v[38:39], v[8:9], v[196:197] op_sel_hi:[1,0,0] neg_lo:[1,0,0] neg_hi:[1,0,0]
v_exp_f32 v132, v132
v_exp_f32 v133, v133
v_pk_fma_f32 v[136:137], v[40:41], v[8:9], v[194:195] op_sel_hi:[1,0,0]
v_exp_f32 v152, v152
buffer_load_dwordx4 a[224:227], v2, s[8:11], s55 offen offset:3072 sc1
v_exp_f32 v153, v153
v_pk_fma_f32 v[156:157], v[40:41], v[8:9], v[196:197] op_sel_hi:[1,0,0] neg_lo:[1,0,0] neg_hi:[1,0,0]
v_exp_f32 v134, v134
v_exp_f32 v135, v135
s_waitcnt lgkmcnt(4)
v_mfma_f32_32x32x16_bf16 v[64:79], v[172:175], a[124:127], v[64:79]
ds_read_b128 v[168:171], v228 offset:51200
v_pk_fma_f32 v[138:139], v[42:43], v[8:9], v[194:195] op_sel_hi:[1,0,0]
v_exp_f32 v154, v154
v_exp_f32 v155, v155
v_pk_fma_f32 v[158:159], v[42:43], v[8:9], v[196:197] op_sel_hi:[1,0,0] neg_lo:[1,0,0] neg_hi:[1,0,0]
v_exp_f32 v136, v136
v_exp_f32 v137, v137
v_pk_fma_f32 v[140:141], v[44:45], v[8:9], v[194:195] op_sel_hi:[1,0,0]
buffer_load_dwordx4 a[228:231], v2, s[8:11], s56 offen offset:3072 sc1
v_exp_f32 v156, v156
v_exp_f32 v157, v157
s_waitcnt lgkmcnt(4)
v_mfma_f32_32x32x16_bf16 v[64:79], v[176:179], a[128:131], v[64:79]
ds_read_b128 v[172:175], v228 offset:54272
v_pk_fma_f32 v[160:161], v[44:45], v[8:9], v[196:197] op_sel_hi:[1,0,0] neg_lo:[1,0,0] neg_hi:[1,0,0]
v_exp_f32 v138, v138
v_exp_f32 v139, v139
v_pk_fma_f32 v[142:143], v[46:47], v[8:9], v[194:195] op_sel_hi:[1,0,0]
v_exp_f32 v158, v158
v_exp_f32 v159, v159
v_pk_fma_f32 v[162:163], v[46:47], v[8:9], v[196:197] op_sel_hi:[1,0,0] neg_lo:[1,0,0] neg_hi:[1,0,0]
v_exp_f32 v140, v140
buffer_load_dwordx4 a[232:235], v2, s[8:11], s57 offen offset:3072 sc1
v_exp_f32 v141, v141
s_waitcnt lgkmcnt(4)
v_mfma_f32_32x32x16_bf16 v[64:79], v[180:183], a[132:135], v[64:79]
ds_read_b128 v[176:179], v228 offset:57344
v_pk_fma_f32 v[144:145], v[48:49], v[8:9], v[194:195] op_sel_hi:[1,0,0]
v_exp_f32 v160, v160
v_exp_f32 v161, v161
v_pk_fma_f32 v[164:165], v[48:49], v[8:9], v[196:197] op_sel_hi:[1,0,0] neg_lo:[1,0,0] neg_hi:[1,0,0]
v_exp_f32 v142, v142
v_exp_f32 v143, v143
v_pk_fma_f32 v[146:147], v[50:51], v[8:9], v[194:195] op_sel_hi:[1,0,0]
v_exp_f32 v162, v162
v_exp_f32 v163, v163
s_waitcnt lgkmcnt(4)
v_mfma_f32_32x32x16_bf16 v[64:79], v[184:187], a[136:139], v[64:79]
ds_read_b128 v[180:183], v228 offset:60416
v_pk_fma_f32 v[166:167], v[50:51], v[8:9], v[196:197] op_sel_hi:[1,0,0] neg_lo:[1,0,0] neg_hi:[1,0,0]
buffer_load_dwordx4 a[236:239], v2, s[8:11], s58 offen offset:3072 sc1
v_exp_f32 v144, v144
v_exp_f32 v145, v145
v_exp_f32 v164, v164
v_exp_f32 v165, v165
v_exp_f32 v146, v146
v_exp_f32 v147, v147
v_exp_f32 v166, v166
v_exp_f32 v167, v167
s_waitcnt lgkmcnt(4)
v_mfma_f32_32x32x16_bf16 v[64:79], v[188:191], a[140:143], v[64:79]
v_pk_add_f32 v[96:97], v[128:129], v[130:131]
v_pk_add_f32 v[106:107], v[148:149], v[150:151]
buffer_load_dwordx4 a[240:243], v3, s[8:11], s54 offen offset:0 sc1
v_pk_add_f32 v[98:99], v[132:133], v[134:135]
v_pk_add_f32 v[108:109], v[152:153], v[154:155]
v_pk_add_f32 v[100:101], v[136:137], v[138:139]
v_pk_add_f32 v[110:111], v[156:157], v[158:159]
v_pk_add_f32 v[102:103], v[140:141], v[142:143]
v_pk_add_f32 v[112:113], v[160:161], v[162:163]
v_pk_add_f32 v[104:105], v[144:145], v[146:147]
s_waitcnt lgkmcnt(3)
v_mfma_f32_32x32x16_bf16 v[64:79], v[168:171], a[144:147], v[64:79]
v_pk_add_f32 v[114:115], v[164:165], v[166:167]
v_pk_add_f32 v[96:97], v[96:97], v[98:99]
v_pk_add_f32 v[106:107], v[106:107], v[108:109]
v_pk_add_f32 v[100:101], v[100:101], v[102:103]
buffer_load_dwordx4 a[244:247], v3, s[8:11], s55 offen offset:0 sc1
v_pk_add_f32 v[110:111], v[110:111], v[112:113]
v_pk_add_f32 v[96:97], v[96:97], v[104:105]
v_pk_add_f32 v[106:107], v[106:107], v[114:115]
v_pk_add_f32 v[96:97], v[96:97], v[100:101]
v_pk_add_f32 v[106:107], v[106:107], v[110:111]
s_waitcnt lgkmcnt(2)
v_mfma_f32_32x32x16_bf16 v[64:79], v[172:175], a[148:151], v[64:79]
v_add_f32 v196, v96, v97
v_add_f32 v198, v106, v107
v_rcp_f32 v196, v196
v_rcp_f32 v198, v198
v_pk_mul_f32 v[128:129], v[128:129], v[196:197] op_sel_hi:[1,0]
buffer_load_dwordx4 a[248:251], v3, s[8:11], s56 offen offset:0 sc1
v_pk_mul_f32 v[130:131], v[130:131], v[196:197] op_sel_hi:[1,0]
v_pk_mul_f32 v[132:133], v[132:133], v[196:197] op_sel_hi:[1,0]
v_pk_mul_f32 v[134:135], v[134:135], v[196:197] op_sel_hi:[1,0]
v_cvt_pk_bf16_f32 v96, v128, v129
s_waitcnt lgkmcnt(1)
v_mfma_f32_32x32x16_bf16 v[64:79], v[176:179], a[152:155], v[64:79]
v_pk_mul_f32 v[136:137], v[136:137], v[196:197] op_sel_hi:[1,0]
v_cvt_pk_bf16_f32 v97, v130, v131
v_pk_mul_f32 v[138:139], v[138:139], v[196:197] op_sel_hi:[1,0]
v_cvt_pk_bf16_f32 v98, v132, v133
v_pk_mul_f32 v[140:141], v[140:141], v[196:197] op_sel_hi:[1,0]
v_cvt_pk_bf16_f32 v99, v134, v135
v_pk_mul_f32 v[142:143], v[142:143], v[196:197] op_sel_hi:[1,0]
buffer_load_dwordx4 a[252:255], v3, s[8:11], s57 offen offset:0 sc1
v_cvt_pk_bf16_f32 v100, v136, v137
v_pk_mul_f32 v[144:145], v[144:145], v[196:197] op_sel_hi:[1,0]
s_waitcnt lgkmcnt(0)
v_mfma_f32_32x32x16_bf16 v[64:79], v[180:183], a[156:159], v[64:79]
v_cvt_pk_bf16_f32 v101, v138, v139
v_pk_mul_f32 v[146:147], v[146:147], v[196:197] op_sel_hi:[1,0]
v_cvt_pk_bf16_f32 v102, v140, v141
v_pk_mul_f32 v[148:149], v[148:149], v[198:199] op_sel_hi:[1,0]
v_cvt_pk_bf16_f32 v103, v142, v143
v_pk_mul_f32 v[150:151], v[150:151], v[198:199] op_sel_hi:[1,0]
v_cvt_pk_bf16_f32 v104, v144, v145
v_pk_mul_f32 v[152:153], v[152:153], v[198:199] op_sel_hi:[1,0]
buffer_load_dwordx4 v[240:243], v3, s[8:11], s58 offen offset:0 sc1
v_cvt_pk_bf16_f32 v105, v146, v147
v_mfma_f32_32x32x16_bf16 v[64:79], v[24:27], v[12:15], v[64:79]
v_pk_mul_f32 v[154:155], v[154:155], v[198:199] op_sel_hi:[1,0]
v_cvt_pk_bf16_f32 v106, v148, v149
v_pk_mul_f32 v[156:157], v[156:157], v[198:199] op_sel_hi:[1,0]
v_cvt_pk_bf16_f32 v107, v150, v151
v_pk_mul_f32 v[158:159], v[158:159], v[198:199] op_sel_hi:[1,0]
v_cvt_pk_bf16_f32 v108, v152, v153
v_pk_mul_f32 v[160:161], v[160:161], v[198:199] op_sel_hi:[1,0]
v_cvt_pk_bf16_f32 v109, v154, v155
v_pk_mul_f32 v[162:163], v[162:163], v[198:199] op_sel_hi:[1,0]
v_cvt_pk_bf16_f32 v110, v156, v157
v_pk_mul_f32 v[164:165], v[164:165], v[198:199] op_sel_hi:[1,0]
v_cvt_pk_bf16_f32 v111, v158, v159
v_pk_mul_f32 v[166:167], v[166:167], v[198:199] op_sel_hi:[1,0]
v_cvt_pk_bf16_f32 v112, v160, v161
v_cvt_pk_bf16_f32 v113, v162, v163
v_cvt_pk_bf16_f32 v114, v164, v165
v_cvt_pk_bf16_f32 v115, v166, v167
s_branch mn_a1j
mn_a1:
s_lshl_b32 s3, s21, 1
s_lshr_b32 s4, s20, 1
s_add_u32 s3, s3, s4
s_lshl_b32 s3, s3, 10
s_add_u32 s3, s3, s27
s_add_u32 s6, s3, 12566528
v_lshlrev_b32 v28, 7, v1
s_mov_b64 exec, 0xff
s_mov_b32 s5, 262144
mn_poll8:
buffer_load_dword v29, v28, s[8:11], s6 offen sc1
s_sub_u32 s5, s5, 1
s_cbranch_scc1 mn_pout9
s_waitcnt vmcnt(0)
v_cmpx_ne_u32 vcc, s69, v29
s_cbranch_execnz mn_poll8
mn_pout9:
s_waitcnt vmcnt(0)
s_mov_b64 exec, -1
s_nop 3
s_lshl_b32 s7, s21, 2
s_add_u32 s7, s7, s20
s_lshl_b32 s33, s7, 8
s_add_u32 s33, s33, s27
s_add_u32 s33, s33, 12451840
v_lshlrev_b32 v14, 3, v6
buffer_load_dwordx2 v[8:9], v14, s[8:11], s33 offen sc1
s_mul_i32 s32, s7, 40960
s_add_u32 s32, s32, s27
s_add_u32 s35, s32, 0
buffer_load_dwordx4 a[0:3], v2, s[8:11], s35 offen offset:0 sc1
buffer_load_dwordx4 a[4:7], v2, s[8:11], s35 offen offset:1024 sc1
buffer_load_dwordx4 a[8:11], v2, s[8:11], s35 offen offset:2048 sc1
buffer_load_dwordx4 a[12:15], v2, s[8:11], s35 offen offset:3072 sc1
s_add_u32 s35, s32, 4096
buffer_load_dwordx4 a[16:19], v2, s[8:11], s35 offen offset:0 sc1
buffer_load_dwordx4 a[20:23], v2, s[8:11], s35 offen offset:1024 sc1
buffer_load_dwordx4 a[24:27], v2, s[8:11], s35 offen offset:2048 sc1
buffer_load_dwordx4 a[28:31], v2, s[8:11], s35 offen offset:3072 sc1
s_add_u32 s35, s32, 8192
buffer_load_dwordx4 a[32:35], v2, s[8:11], s35 offen offset:0 sc1
buffer_load_dwordx4 a[36:39], v2, s[8:11], s35 offen offset:1024 sc1
buffer_load_dwordx4 a[40:43], v2, s[8:11], s35 offen offset:2048 sc1
buffer_load_dwordx4 a[44:47], v2, s[8:11], s35 offen offset:3072 sc1
s_add_u32 s35, s32, 12288
buffer_load_dwordx4 a[48:51], v2, s[8:11], s35 offen offset:0 sc1
buffer_load_dwordx4 a[52:55], v2, s[8:11], s35 offen offset:1024 sc1
buffer_load_dwordx4 a[56:59], v2, s[8:11], s35 offen offset:2048 sc1
buffer_load_dwordx4 a[60:63], v2, s[8:11], s35 offen offset:3072 sc1
s_waitcnt vmcnt(17)
s_barrier
ds_read_b128 v[96:99], v2 offset:0
ds_read_b128 v[100:103], v2 offset:1024
ds_read_b128 v[104:107], v2 offset:2048
ds_read_b128 v[108:111], v2 offset:3072
ds_read_b128 v[112:115], v2 offset:4096
ds_read_b128 v[116:119], v2 offset:5120
s_waitcnt vmcnt(15)
s_waitcnt lgkmcnt(3)
v_mfma_f32_32x32x16_bf16 v[32:47], v[96:99], a[0:3], 0
ds_read_b128 v[120:123], v2 offset:6144
s_add_u32 s35, s32, 16384
buffer_load_dwordx4 a[64:67], v2, s[8:11], s35 offen offset:0 sc1
v_mfma_f32_32x32x16_bf16 v[48:63], v[100:103], a[0:3], 0
ds_read_b128 v[124:127], v2 offset:7168
v_mfma_f32_32x32x16_bf16 v[64:79], v[104:107], a[0:3], 0
ds_read_b128 v[128:131], v2 offset:8192
s_waitcnt vmcnt(15)
s_waitcnt lgkmcnt(3)
v_mfma_f32_32x32x16_bf16 v[32:47], v[108:111], a[4:7], v[32:47]
ds_read_b128 v[132:135], v2 offset:9216
buffer_load_dwordx4 a[68:71], v2, s[8:11], s35 offen offset:1024 sc1
v_mfma_f32_32x32x16_bf16 v[48:63], v[112:115], a[4:7], v[48:63]
ds_read_b128 v[136:139], v2 offset:10240
v_mfma_f32_32x32x16_bf16 v[64:79], v[116:119], a[4:7], v[64:79]
ds_read_b128 v[140:143], v2 offset:11264
s_waitcnt vmcnt(15)
s_waitcnt lgkmcnt(3)
v_mfma_f32_32x32x16_bf16 v[32:47], v[120:123], a[8:11], v[32:47]
ds_read_b128 v[144:147], v2 offset:12288
buffer_load_dwordx4 a[72:75], v2, s[8:11], s35 offen offset:2048 sc1
v_mfma_f32_32x32x16_bf16 v[48:63], v[124:127], a[8:11], v[48:63]
ds_read_b128 v[148:151], v2 offset:13312
v_mul_f32 v8, 0x3acccccd, v8
v_mul_f32 v9, 0x3acccccd, v9
v_mfma_f32_32x32x16_bf16 v[64:79], v[128:131], a[8:11], v[64:79]
ds_read_b128 v[152:155], v2 offset:14336
s_waitcnt vmcnt(15)
s_waitcnt lgkmcnt(3)
v_mfma_f32_32x32x16_bf16 v[32:47], v[132:135], a[12:15], v[32:47]
ds_read_b128 v[156:159], v2 offset:15360
buffer_load_dwordx4 a[76:79], v2, s[8:11], s35 offen offset:3072 sc1
v_mfma_f32_32x32x16_bf16 v[48:63], v[136:139], a[12:15], v[48:63]
ds_read_b128 v[160:163], v2 offset:16384
v_fma_f32 v9, -v8, v8, v9
v_max_f32 v9, 0, v9
v_mfma_f32_32x32x16_bf16 v[64:79], v[140:143], a[12:15], v[64:79]
ds_read_b128 v[164:167], v2 offset:18432
s_waitcnt vmcnt(15)
s_waitcnt lgkmcnt(3)
v_mfma_f32_32x32x16_bf16 v[32:47], v[144:147], a[16:19], v[32:47]
ds_read_b128 v[96:99], v2 offset:19456
s_add_u32 s35, s32, 20480
buffer_load_dwordx4 a[80:83], v2, s[8:11], s35 offen offset:0 sc1
v_mfma_f32_32x32x16_bf16 v[48:63], v[148:151], a[16:19], v[48:63]
ds_read_b128 v[100:103], v2 offset:21504
v_add_f32 v9, 0x3727c5ac, v9
v_rsq_f32 v10, v9
v_mfma_f32_32x32x16_bf16 v[64:79], v[152:155], a[16:19], v[64:79]
ds_read_b128 v[104:107], v2 offset:22528
s_waitcnt vmcnt(15)
s_waitcnt lgkmcnt(4)
v_mfma_f32_32x32x16_bf16 v[32:47], v[156:159], a[20:23], v[32:47]
ds_read_b128 v[108:111], v2 offset:24576
buffer_load_dwordx4 a[84:87], v2, s[8:11], s35 offen offset:1024 sc1
v_mfma_f32_32x32x16_bf16 v[48:63], v[160:163], a[20:23], v[48:63]
ds_read_b128 v[112:115], v2 offset:25600
v_sub_f32 v192, 0, v8
v_cvt_pk_bf16_f32 v193, v192, v192
s_waitcnt vmcnt(15)
s_waitcnt lgkmcnt(4)
v_mfma_f32_32x32x16_bf16 v[32:47], v[164:167], a[24:27], v[32:47]
ds_read_b128 v[116:119], v2 offset:27648
buffer_load_dwordx4 a[88:91], v2, s[8:11], s35 offen offset:2048 sc1
v_mfma_f32_32x32x16_bf16 v[48:63], v[96:99], a[24:27], v[48:63]
ds_read_b128 v[120:123], v2 offset:28672
v_lshlrev_b32 v194, 16, v193
v_sub_f32 v194, v192, v194
s_waitcnt vmcnt(15)
s_waitcnt lgkmcnt(4)
v_mfma_f32_32x32x16_bf16 v[32:47], v[100:103], a[28:31], v[32:47]
ds_read_b128 v[124:127], v2 offset:30720
buffer_load_dwordx4 a[92:95], v2, s[8:11], s35 offen offset:3072 sc1
v_mfma_f32_32x32x16_bf16 v[48:63], v[104:107], a[28:31], v[48:63]
ds_read_b128 v[128:131], v2 offset:31744
v_cvt_pk_bf16_f32 v194, v194, v194
v_mov_b32 v195, 0xffff
s_waitcnt vmcnt(15)
s_waitcnt lgkmcnt(4)
v_mfma_f32_32x32x16_bf16 v[32:47], v[108:111], a[32:35], v[32:47]
ds_read_b128 v[132:135], v2 offset:33792
s_add_u32 s35, s32, 24576
buffer_load_dwordx4 a[96:99], v2, s[8:11], s35 offen offset:0 sc1
v_mfma_f32_32x32x16_bf16 v[48:63], v[112:115], a[32:35], v[48:63]
ds_read_b128 v[136:139], v2 offset:34816
v_bfi_b32 v196, v195, v194, v193
v_bfi_b32 v197, v195, v193, v194
s_waitcnt vmcnt(15)
s_waitcnt lgkmcnt(4)
v_mfma_f32_32x32x16_bf16 v[32:47], v[116:119], a[36:39], v[32:47]
ds_read_b128 v[140:143], v2 offset:36864
buffer_load_dwordx4 a[100:103], v2, s[8:11], s35 offen offset:1024 sc1
v_mfma_f32_32x32x16_bf16 v[48:63], v[120:123], a[36:39], v[48:63]
ds_read_b128 v[144:147], v2 offset:37888
v_and_b32 v198, v195, v194
v_cmp_eq_u32 vcc, 1, v7
s_waitcnt vmcnt(15)
s_waitcnt lgkmcnt(4)
v_mfma_f32_32x32x16_bf16 v[32:47], v[124:127], a[40:43], v[32:47]
ds_read_b128 v[148:151], v2 offset:39936
buffer_load_dwordx4 a[104:107], v2, s[8:11], s35 offen offset:2048 sc1
v_mfma_f32_32x32x16_bf16 v[48:63], v[128:131], a[40:43], v[48:63]
ds_read_b128 v[152:155], v2 offset:40960
v_cndmask_b32 v12, v193, v196, vcc
v_cndmask_b32 v13, v196, v197, vcc
s_waitcnt vmcnt(15)
s_waitcnt lgkmcnt(4)
v_mfma_f32_32x32x16_bf16 v[32:47], v[132:135], a[44:47], v[32:47]
ds_read_b128 v[156:159], v2 offset:43008
buffer_load_dwordx4 a[108:111], v2, s[8:11], s35 offen offset:3072 sc1
v_mfma_f32_32x32x16_bf16 v[48:63], v[136:139], a[44:47], v[48:63]
ds_read_b128 v[160:163], v2 offset:44032
v_cndmask_b32 v14, v197, v193, vcc
v_cndmask_b32 v15, v193, v198, vcc
s_waitcnt vmcnt(15)
s_waitcnt lgkmcnt(4)
v_mfma_f32_32x32x16_bf16 v[32:47], v[140:143], a[48:51], v[32:47]
ds_read_b128 v[164:167], v2 offset:46080
s_add_u32 s35, s32, 28672
buffer_load_dwordx4 a[112:115], v2, s[8:11], s35 offen offset:0 sc1
v_mfma_f32_32x32x16_bf16 v[48:63], v[144:147], a[48:51], v[48:63]
ds_read_b128 v[96:99], v2 offset:47104
v_mul_f32 v8, 0x3fb8aa3b, v10
s_waitcnt vmcnt(15)
s_waitcnt lgkmcnt(4)
v_mfma_f32_32x32x16_bf16 v[32:47], v[148:151], a[52:55], v[32:47]
ds_read_b128 v[100:103], v2 offset:49152
buffer_load_dwordx4 a[116:119], v2, s[8:11], s35 offen offset:1024 sc1
v_mfma_f32_32x32x16_bf16 v[48:63], v[152:155], a[52:55], v[48:63]
ds_read_b128 v[104:107], v2 offset:50176
s_waitcnt vmcnt(15)
s_waitcnt lgkmcnt(4)
v_mfma_f32_32x32x16_bf16 v[32:47], v[156:159], a[56:59], v[32:47]
ds_read_b128 v[108:111], v2 offset:52224
buffer_load_dwordx4 a[120:123], v2, s[8:11], s35 offen offset:2048 sc1
v_mfma_f32_32x32x16_bf16 v[48:63], v[160:163], a[56:59], v[48:63]
ds_read_b128 v[112:115], v2 offset:53248
s_waitcnt vmcnt(15)
s_waitcnt lgkmcnt(4)
v_mfma_f32_32x32x16_bf16 v[32:47], v[164:167], a[60:63], v[32:47]
ds_read_b128 v[116:119], v2 offset:55296
buffer_load_dwordx4 a[124:127], v2, s[8:11], s35 offen offset:3072 sc1
v_mfma_f32_32x32x16_bf16 v[48:63], v[96:99], a[60:63], v[48:63]
ds_read_b128 v[120:123], v2 offset:56320
s_waitcnt vmcnt(15)
s_waitcnt lgkmcnt(4)
v_mfma_f32_32x32x16_bf16 v[32:47], v[100:103], a[64:67], v[32:47]
ds_read_b128 v[124:127], v2 offset:58368
s_add_u32 s35, s32, 32768
buffer_load_dwordx4 a[128:131], v2, s[8:11], s35 offen offset:0 sc1
v_mfma_f32_32x32x16_bf16 v[48:63], v[104:107], a[64:67], v[48:63]
ds_read_b128 v[128:131], v2 offset:59392
s_waitcnt vmcnt(15)
s_waitcnt lgkmcnt(4)
v_mfma_f32_32x32x16_bf16 v[32:47], v[108:111], a[68:71], v[32:47]
ds_read_b128 v[132:135], v228 offset:0
buffer_load_dwordx4 a[132:135], v2, s[8:11], s35 offen offset:1024 sc1
v_mfma_f32_32x32x16_bf16 v[48:63], v[112:115], a[68:71], v[48:63]
ds_read_b128 v[136:139], v228 offset:1024
s_waitcnt vmcnt(15)
s_waitcnt lgkmcnt(4)
v_mfma_f32_32x32x16_bf16 v[32:47], v[116:119], a[72:75], v[32:47]
ds_read_b128 v[140:143], v228 offset:3072
buffer_load_dwordx4 a[136:139], v2, s[8:11], s35 offen offset:2048 sc1
v_mfma_f32_32x32x16_bf16 v[48:63], v[120:123], a[72:75], v[48:63]
ds_read_b128 v[144:147], v228 offset:4096
s_waitcnt vmcnt(15)
s_waitcnt lgkmcnt(4)
v_mfma_f32_32x32x16_bf16 v[32:47], v[124:127], a[76:79], v[32:47]
ds_read_b128 v[148:151], v228 offset:6144
buffer_load_dwordx4 a[140:143], v2, s[8:11], s35 offen offset:3072 sc1
v_mfma_f32_32x32x16_bf16 v[48:63], v[128:131], a[76:79], v[48:63]
ds_read_b128 v[152:155], v228 offset:7168
s_waitcnt vmcnt(15)
s_waitcnt lgkmcnt(4)
v_mfma_f32_32x32x16_bf16 v[32:47], v[132:135], a[80:83], v[32:47]
ds_read_b128 v[156:159], v228 offset:9216
s_add_u32 s35, s32, 36864
buffer_load_dwordx4 a[144:147], v2, s[8:11], s35 offen offset:0 sc1
v_mfma_f32_32x32x16_bf16 v[48:63], v[136:139], a[80:83], v[48:63]
ds_read_b128 v[160:163], v228 offset:10240
s_waitcnt vmcnt(15)
s_waitcnt lgkmcnt(4)
v_mfma_f32_32x32x16_bf16 v[32:47], v[140:143], a[84:87], v[32:47]
ds_read_b128 v[164:167], v228 offset:12288
buffer_load_dwordx4 a[148:151], v2, s[8:11], s35 offen offset:1024 sc1
v_mfma_f32_32x32x16_bf16 v[48:63], v[144:147], a[84:87], v[48:63]
ds_read_b128 v[96:99], v228 offset:13312
s_waitcnt vmcnt(15)
s_waitcnt lgkmcnt(4)
v_mfma_f32_32x32x16_bf16 v[32:47], v[148:151], a[88:91], v[32:47]
ds_read_b128 v[100:103], v228 offset:15360
buffer_load_dwordx4 a[152:155], v2, s[8:11], s35 offen offset:2048 sc1
v_mfma_f32_32x32x16_bf16 v[48:63], v[152:155], a[88:91], v[48:63]
ds_read_b128 v[104:107], v228 offset:16384
s_waitcnt vmcnt(15)
s_waitcnt lgkmcnt(4)
v_mfma_f32_32x32x16_bf16 v[32:47], v[156:159], a[92:95], v[32:47]
ds_read_b128 v[108:111], v228 offset:18432
buffer_load_dwordx4 a[156:159], v2, s[8:11], s35 offen offset:3072 sc1
v_mfma_f32_32x32x16_bf16 v[48:63], v[160:163], a[92:95], v[48:63]
ds_read_b128 v[112:115], v228 offset:19456
s_waitcnt vmcnt(15)
s_waitcnt lgkmcnt(4)
v_mfma_f32_32x32x16_bf16 v[32:47], v[164:167], a[96:99], v[32:47]
ds_read_b128 v[116:119], v228 offset:21504
buffer_load_dwordx4 v[16:19], v2, s[8:11], s59 offen offset:0 sc1
v_mfma_f32_32x32x16_bf16 v[48:63], v[96:99], a[96:99], v[48:63]
ds_read_b128 v[120:123], v228 offset:22528
s_waitcnt vmcnt(15)
s_waitcnt lgkmcnt(4)
v_mfma_f32_32x32x16_bf16 v[32:47], v[100:103], a[100:103], v[32:47]
ds_read_b128 v[124:127], v228 offset:24576
buffer_load_dwordx4 v[20:23], v2, s[8:11], s59 offen offset:1024 sc1
v_mfma_f32_32x32x16_bf16 v[48:63], v[104:107], a[100:103], v[48:63]
ds_read_b128 v[128:131], v228 offset:25600
s_waitcnt vmcnt(15)
s_waitcnt lgkmcnt(4)
v_mfma_f32_32x32x16_bf16 v[32:47], v[108:111], a[104:107], v[32:47]
ds_read_b128 v[132:135], v228 offset:27648
buffer_load_dwordx4 v[24:27], v2, s[8:11], s59 offen offset:2048 sc1
v_mfma_f32_32x32x16_bf16 v[48:63], v[112:115], a[104:107], v[48:63]
ds_read_b128 v[136:139], v228 offset:28672
s_waitcnt vmcnt(15)
s_waitcnt lgkmcnt(4)
v_mfma_f32_32x32x16_bf16 v[32:47], v[116:119], a[108:111], v[32:47]
ds_read_b128 v[140:143], v228 offset:30720
buffer_load_dwordx4 v[28:31], v2, s[8:11], s59 offen offset:3072 sc1
v_mfma_f32_32x32x16_bf16 v[48:63], v[120:123], a[108:111], v[48:63]
ds_read_b128 v[144:147], v228 offset:31744
s_waitcnt vmcnt(15)
s_waitcnt lgkmcnt(4)
v_mfma_f32_32x32x16_bf16 v[32:47], v[124:127], a[112:115], v[32:47]
ds_read_b128 v[148:151], v228 offset:33792
s_mul_i32 s3, s24, 102400
s_mul_i32 s4, s20, 5120
s_add_u32 s3, s3, s4
s_add_u32 s54, s3, 3145728
s_add_u32 s55, s54, 20480
s_add_u32 s56, s54, 40960
s_add_u32 s57, s54, 61440
s_add_u32 s58, s54, 81920
buffer_load_dwordx4 a[160:163], v2, s[8:11], s54 offen offset:0 sc1
v_mfma_f32_32x32x16_bf16 v[48:63], v[128:131], a[112:115], v[48:63]
ds_read_b128 v[152:155], v228 offset:34816
s_waitcnt vmcnt(15)
s_waitcnt lgkmcnt(4)
v_mfma_f32_32x32x16_bf16 v[32:47], v[132:135], a[116:119], v[32:47]
ds_read_b128 v[156:159], v228 offset:36864
buffer_load_dwordx4 a[164:167], v2, s[8:11], s55 offen offset:0 sc1
v_mfma_f32_32x32x16_bf16 v[48:63], v[136:139], a[116:119], v[48:63]
ds_read_b128 v[160:163], v228 offset:37888
s_waitcnt vmcnt(15)
s_waitcnt lgkmcnt(4)
v_mfma_f32_32x32x16_bf16 v[32:47], v[140:143], a[120:123], v[32:47]
ds_read_b128 v[164:167], v228 offset:39936
buffer_load_dwordx4 a[168:171], v2, s[8:11], s56 offen offset:0 sc1
v_mfma_f32_32x32x16_bf16 v[48:63], v[144:147], a[120:123], v[48:63]
ds_read_b128 v[96:99], v228 offset:40960
s_waitcnt vmcnt(15)
s_waitcnt lgkmcnt(4)
v_mfma_f32_32x32x16_bf16 v[32:47], v[148:151], a[124:127], v[32:47]
ds_read_b128 v[100:103], v228 offset:43008
buffer_load_dwordx4 a[172:175], v2, s[8:11], s57 offen offset:0 sc1
v_mfma_f32_32x32x16_bf16 v[48:63], v[152:155], a[124:127], v[48:63]
ds_read_b128 v[104:107], v228 offset:44032
s_waitcnt vmcnt(15)
s_waitcnt lgkmcnt(4)
v_mfma_f32_32x32x16_bf16 v[32:47], v[156:159], a[128:131], v[32:47]
ds_read_b128 v[108:111], v228 offset:46080
buffer_load_dwordx4 a[176:179], v2, s[8:11], s58 offen offset:0 sc1
v_mfma_f32_32x32x16_bf16 v[48:63], v[160:163], a[128:131], v[48:63]
ds_read_b128 v[112:115], v228 offset:47104
s_waitcnt vmcnt(15)
s_waitcnt lgkmcnt(4)
v_mfma_f32_32x32x16_bf16 v[32:47], v[164:167], a[132:135], v[32:47]
ds_read_b128 v[116:119], v228 offset:49152
buffer_load_dwordx4 a[180:183], v2, s[8:11], s54 offen offset:1024 sc1
v_mfma_f32_32x32x16_bf16 v[48:63], v[96:99], a[132:135], v[48:63]
ds_read_b128 v[120:123], v228 offset:50176
s_waitcnt vmcnt(15)
s_waitcnt lgkmcnt(4)
v_mfma_f32_32x32x16_bf16 v[32:47], v[100:103], a[136:139], v[32:47]
ds_read_b128 v[124:127], v228 offset:52224
buffer_load_dwordx4 a[184:187], v2, s[8:11], s55 offen offset:1024 sc1
v_mfma_f32_32x32x16_bf16 v[48:63], v[104:107], a[136:139], v[48:63]
ds_read_b128 v[128:131], v228 offset:53248
s_waitcnt vmcnt(15)
s_waitcnt lgkmcnt(4)
v_mfma_f32_32x32x16_bf16 v[32:47], v[108:111], a[140:143], v[32:47]
ds_read_b128 v[132:135], v228 offset:55296
buffer_load_dwordx4 a[188:191], v2, s[8:11], s56 offen offset:1024 sc1
v_mfma_f32_32x32x16_bf16 v[48:63], v[112:115], a[140:143], v[48:63]
ds_read_b128 v[136:139], v228 offset:56320
s_waitcnt vmcnt(15)
s_waitcnt lgkmcnt(4)
v_mfma_f32_32x32x16_bf16 v[32:47], v[116:119], a[144:147], v[32:47]
ds_read_b128 v[140:143], v228 offset:58368
buffer_load_dwordx4 a[192:195], v2, s[8:11], s57 offen offset:1024 sc1
v_mfma_f32_32x32x16_bf16 v[48:63], v[120:123], a[144:147], v[48:63]
ds_read_b128 v[144:147], v228 offset:59392
s_waitcnt vmcnt(15)
s_waitcnt lgkmcnt(4)
v_mfma_f32_32x32x16_bf16 v[32:47], v[124:127], a[148:151], v[32:47]
ds_read_b128 v[168:171], v2 offset:17408
buffer_load_dwordx4 a[196:199], v2, s[8:11], s58 offen offset:1024 sc1
v_mfma_f32_32x32x16_bf16 v[48:63], v[128:131], a[148:151], v[48:63]
ds_read_b128 v[172:175], v2 offset:20480
s_waitcnt vmcnt(15)
s_waitcnt lgkmcnt(4)
v_mfma_f32_32x32x16_bf16 v[32:47], v[132:135], a[152:155], v[32:47]
ds_read_b128 v[176:179], v2 offset:23552
buffer_load_dwordx4 a[200:203], v2, s[8:11], s54 offen offset:2048 sc1
v_mfma_f32_32x32x16_bf16 v[48:63], v[136:139], a[152:155], v[48:63]
ds_read_b128 v[180:183], v2 offset:26624
s_waitcnt vmcnt(15)
s_waitcnt lgkmcnt(4)
v_mfma_f32_32x32x16_bf16 v[32:47], v[140:143], a[156:159], v[32:47]
ds_read_b128 v[184:187], v2 offset:29696
buffer_load_dwordx4 a[204:207], v2, s[8:11], s55 offen offset:2048 sc1
v_mfma_f32_32x32x16_bf16 v[48:63], v[144:147], a[156:159], v[48:63]
s_waitcnt vmcnt(12)
v_mfma_f32_32x32x16_bf16 v[32:47], v[16:19], v[12:15], v[32:47]
v_mfma_f32_32x32x16_bf16 v[48:63], v[20:23], v[12:15], v[48:63]
s_waitcnt lgkmcnt(4)
v_mfma_f32_32x32x16_bf16 v[64:79], v[168:171], a[20:23], v[64:79]
ds_read_b128 v[188:191], v2 offset:32768
s_waitcnt lgkmcnt(4)
v_mfma_f32_32x32x16_bf16 v[64:79], v[172:175], a[24:27], v[64:79]
ds_read_b128 v[168:171], v2 offset:35840
s_lshl_b32 s3, s20, 5
v_lshl_add_u32 v200, v7, 7, v6
v_add_u32 v200, s3, v200
v_mul_u32_u24 v200, 160, v200
s_lshr_b32 s36, s20, 1
s_and_b32 s37, s20, 1
v_lshrrev_b32 v201, 2, v1
v_mul_u32_u24 v201, 160, v201
v_and_b32 v202, 3, v1
v_lshl_add_u32 v201, v202, 3, v201
s_mul_i32 s3, s36, 20480
s_lshl_b32 s4, s37, 5
s_add_u32 s4, s4, 64
v_add_u32 v201, s3, v201
v_add_u32 v202, s4, v201
v_max3_f32 v128, v32, v33, v34
buffer_load_dwordx4 a[208:211], v2, s[8:11], s56 offen offset:2048 sc1
s_waitcnt lgkmcnt(4)
v_mfma_f32_32x32x16_bf16 v[64:79], v[176:179], a[28:31], v[64:79]
ds_read_b128 v[172:175], v2 offset:38912
v_min3_f32 v136, v32, v33, v34
v_max3_f32 v129, v35, v36, v37
v_min3_f32 v137, v35, v36, v37
v_max3_f32 v130, v38, v39, v40
s_waitcnt lgkmcnt(4)
v_mfma_f32_32x32x16_bf16 v[64:79], v[180:183], a[32:35], v[64:79]
ds_read_b128 v[176:179], v2 offset:41984
v_min3_f32 v138, v38, v39, v40
v_max3_f32 v131, v41, v42, v43
v_min3_f32 v139, v41, v42, v43
v_max3_f32 v132, v44, v45, v46
s_waitcnt lgkmcnt(4)
v_mfma_f32_32x32x16_bf16 v[64:79], v[184:187], a[36:39], v[64:79]
ds_read_b128 v[180:183], v2 offset:45056
v_min3_f32 v140, v44, v45, v46
v_max3_f32 v133, v47, v48, v49
buffer_load_dwordx4 a[212:215], v2, s[8:11], s57 offen offset:2048 sc1
v_min3_f32 v141, v47, v48, v49
v_max3_f32 v128, v128, v50, v51
s_waitcnt lgkmcnt(4)
v_mfma_f32_32x32x16_bf16 v[64:79], v[188:191], a[40:43], v[64:79]
ds_read_b128 v[184:187], v2 offset:48128
v_min3_f32 v136, v136, v50, v51
v_max3_f32 v129, v129, v130, v131
v_min3_f32 v137, v137, v138, v139
v_max3_f32 v128, v128, v132, v133
s_waitcnt lgkmcnt(4)
v_mfma_f32_32x32x16_bf16 v[64:79], v[168:171], a[44:47], v[64:79]
ds_read_b128 v[188:191], v2 offset:51200
v_min3_f32 v136, v136, v140, v141
v_max_f32 v128, v128, v129
v_min_f32 v136, v136, v137
v_mul_f32 v194, v128, -v8
buffer_load_dwordx4 a[216:219], v2, s[8:11], s58 offen offset:2048 sc1
s_waitcnt lgkmcnt(4)
v_mfma_f32_32x32x16_bf16 v[64:79], v[172:175], a[48:51], v[64:79]
ds_read_b128 v[168:171], v2 offset:54272
v_mul_f32 v196, v136, v8
v_pk_fma_f32 v[128:129], v[32:33], v[8:9], v[194:195] op_sel_hi:[1,0,0]
v_pk_fma_f32 v[148:149], v[32:33], v[8:9], v[196:197] op_sel_hi:[1,0,0] neg_lo:[1,0,0] neg_hi:[1,0,0]
v_pk_fma_f32 v[130:131], v[34:35], v[8:9], v[194:195] op_sel_hi:[1,0,0]
s_waitcnt lgkmcnt(4)
v_mfma_f32_32x32x16_bf16 v[64:79], v[176:179], a[52:55], v[64:79]
ds_read_b128 v[172:175], v2 offset:57344
v_pk_fma_f32 v[150:151], v[34:35], v[8:9], v[196:197] op_sel_hi:[1,0,0] neg_lo:[1,0,0] neg_hi:[1,0,0]
v_exp_f32 v128, v128
v_exp_f32 v129, v129
v_pk_fma_f32 v[132:133], v[36:37], v[8:9], v[194:195] op_sel_hi:[1,0,0]
s_waitcnt lgkmcnt(4)
v_mfma_f32_32x32x16_bf16 v[64:79], v[180:183], a[56:59], v[64:79]
ds_read_b128 v[176:179], v2 offset:60416
v_exp_f32 v148, v148
v_exp_f32 v149, v149
v_pk_fma_f32 v[152:153], v[36:37], v[8:9], v[196:197] op_sel_hi:[1,0,0] neg_lo:[1,0,0] neg_hi:[1,0,0]
buffer_load_dwordx4 a[220:223], v2, s[8:11], s54 offen offset:3072 sc1
v_exp_f32 v130, v130
s_waitcnt lgkmcnt(4)
v_mfma_f32_32x32x16_bf16 v[64:79], v[184:187], a[60:63], v[64:79]
ds_read_b128 v[180:183], v228 offset:2048
v_exp_f32 v131, v131
v_pk_fma_f32 v[134:135], v[38:39], v[8:9], v[194:195] op_sel_hi:[1,0,0]
v_exp_f32 v150, v150
v_exp_f32 v151, v151
s_waitcnt lgkmcnt(4)
v_mfma_f32_32x32x16_bf16 v[64:79], v[188:191], a[64:67], v[64:79]
ds_read_b128 v[184:187], v228 offset:5120
v_pk_fma_f32 v[154:155], v[38:39], v[8:9], v[196:197] op_sel_hi:[1,0,0] neg_lo:[1,0,0] neg_hi:[1,0,0]
v_exp_f32 v132, v132
v_exp_f32 v133, v133
v_pk_fma_f32 v[136:137], v[40:41], v[8:9], v[194:195] op_sel_hi:[1,0,0]
s_waitcnt lgkmcnt(4)
v_mfma_f32_32x32x16_bf16 v[64:79], v[168:171], a[68:71], v[64:79]
ds_read_b128 v[188:191], v228 offset:8192
v_exp_f32 v152, v152
buffer_load_dwordx4 a[224:227], v2, s[8:11], s55 offen offset:3072 sc1
v_exp_f32 v153, v153
v_pk_fma_f32 v[156:157], v[40:41], v[8:9], v[196:197] op_sel_hi:[1,0,0] neg_lo:[1,0,0] neg_hi:[1,0,0]
v_exp_f32 v134, v134
s_waitcnt lgkmcnt(4)
v_mfma_f32_32x32x16_bf16 v[64:79], v[172:175], a[72:75], v[64:79]
ds_read_b128 v[168:171], v228 offset:11264
v_exp_f32 v135, v135
v_pk_fma_f32 v[138:139], v[42:43], v[8:9], v[194:195] op_sel_hi:[1,0,0]
v_exp_f32 v154, v154
v_exp_f32 v155, v155
s_waitcnt lgkmcnt(4)
v_mfma_f32_32x32x16_bf16 v[64:79], v[176:179], a[76:79], v[64:79]
ds_read_b128 v[172:175], v228 offset:14336
v_pk_fma_f32 v[158:159], v[42:43], v[8:9], v[196:197] op_sel_hi:[1,0,0] neg_lo:[1,0,0] neg_hi:[1,0,0]
v_exp_f32 v136, v136
v_exp_f32 v137, v137
v_pk_fma_f32 v[140:141], v[44:45], v[8:9], v[194:195] op_sel_hi:[1,0,0]
buffer_load_dwordx4 a[228:231], v2, s[8:11], s56 offen offset:3072 sc1
s_waitcnt lgkmcnt(4)
v_mfma_f32_32x32x16_bf16 v[64:79], v[180:183], a[80:83], v[64:79]
ds_read_b128 v[176:179], v228 offset:17408
v_exp_f32 v156, v156
v_exp_f32 v157, v157
v_pk_fma_f32 v[160:161], v[44:45], v[8:9], v[196:197] op_sel_hi:[1,0,0] neg_lo:[1,0,0] neg_hi:[1,0,0]
v_exp_f32 v138, v138
s_waitcnt lgkmcnt(4)
v_mfma_f32_32x32x16_bf16 v[64:79], v[184:187], a[84:87], v[64:79]
ds_read_b128 v[180:183], v228 offset:20480
v_exp_f32 v139, v139
v_pk_fma_f32 v[142:143], v[46:47], v[8:9], v[194:195] op_sel_hi:[1,0,0]
v_exp_f32 v158, v158
v_exp_f32 v159, v159
s_waitcnt lgkmcnt(4)
v_mfma_f32_32x32x16_bf16 v[64:79], v[188:191], a[88:91], v[64:79]
ds_read_b128 v[184:187], v228 offset:23552
v_pk_fma_f32 v[162:163], v[46:47], v[8:9], v[196:197] op_sel_hi:[1,0,0] neg_lo:[1,0,0] neg_hi:[1,0,0]
v_exp_f32 v140, v140
buffer_load_dwordx4 a[232:235], v2, s[8:11], s57 offen offset:3072 sc1
v_exp_f32 v141, v141
v_pk_fma_f32 v[144:145], v[48:49], v[8:9], v[194:195] op_sel_hi:[1,0,0]
s_waitcnt lgkmcnt(4)
v_mfma_f32_32x32x16_bf16 v[64:79], v[168:171], a[92:95], v[64:79]
ds_read_b128 v[188:191], v228 offset:26624
v_exp_f32 v160, v160
v_exp_f32 v161, v161
v_pk_fma_f32 v[164:165], v[48:49], v[8:9], v[196:197] op_sel_hi:[1,0,0] neg_lo:[1,0,0] neg_hi:[1,0,0]
v_exp_f32 v142, v142
s_waitcnt lgkmcnt(4)
v_mfma_f32_32x32x16_bf16 v[64:79], v[172:175], a[96:99], v[64:79]
ds_read_b128 v[168:171], v228 offset:29696
v_exp_f32 v143, v143
v_pk_fma_f32 v[146:147], v[50:51], v[8:9], v[194:195] op_sel_hi:[1,0,0]
v_exp_f32 v162, v162
v_exp_f32 v163, v163
s_waitcnt lgkmcnt(4)
v_mfma_f32_32x32x16_bf16 v[64:79], v[176:179], a[100:103], v[64:79]
ds_read_b128 v[172:175], v228 offset:32768
v_pk_fma_f32 v[166:167], v[50:51], v[8:9], v[196:197] op_sel_hi:[1,0,0] neg_lo:[1,0,0] neg_hi:[1,0,0]
buffer_load_dwordx4 a[236:239], v2, s[8:11], s58 offen offset:3072 sc1
v_exp_f32 v144, v144
v_exp_f32 v145, v145
v_exp_f32 v164, v164
s_waitcnt lgkmcnt(4)
v_mfma_f32_32x32x16_bf16 v[64:79], v[180:183], a[104:107], v[64:79]
ds_read_b128 v[176:179], v228 offset:35840
v_exp_f32 v165, v165
v_exp_f32 v146, v146
v_exp_f32 v147, v147
v_exp_f32 v166, v166
s_waitcnt lgkmcnt(4)
v_mfma_f32_32x32x16_bf16 v[64:79], v[184:187], a[108:111], v[64:79]
ds_read_b128 v[180:183], v228 offset:38912
v_exp_f32 v167, v167
v_pk_add_f32 v[96:97], v[128:129], v[130:131]
v_pk_add_f32 v[106:107], v[148:149], v[150:151]
buffer_load_dwordx4 a[240:243], v3, s[8:11], s54 offen offset:0 sc1
v_pk_add_f32 v[98:99], v[132:133], v[134:135]
s_waitcnt lgkmcnt(4)
v_mfma_f32_32x32x16_bf16 v[64:79], v[188:191], a[112:115], v[64:79]
ds_read_b128 v[184:187], v228 offset:41984
v_pk_add_f32 v[108:109], v[152:153], v[154:155]
v_pk_add_f32 v[100:101], v[136:137], v[138:139]
v_pk_add_f32 v[110:111], v[156:157], v[158:159]
v_pk_add_f32 v[102:103], v[140:141], v[142:143]
s_waitcnt lgkmcnt(4)
v_mfma_f32_32x32x16_bf16 v[64:79], v[168:171], a[116:119], v[64:79]
ds_read_b128 v[188:191], v228 offset:45056
v_pk_add_f32 v[112:113], v[160:161], v[162:163]
v_pk_add_f32 v[104:105], v[144:145], v[146:147]
v_pk_add_f32 v[114:115], v[164:165], v[166:167]
v_pk_add_f32 v[96:97], v[96:97], v[98:99]
s_waitcnt lgkmcnt(4)
v_mfma_f32_32x32x16_bf16 v[64:79], v[172:175], a[120:123], v[64:79]
ds_read_b128 v[168:171], v228 offset:48128
v_pk_add_f32 v[106:107], v[106:107], v[108:109]
v_pk_add_f32 v[100:101], v[100:101], v[102:103]
buffer_load_dwordx4 a[244:247], v3, s[8:11], s55 offen offset:0 sc1
v_pk_add_f32 v[110:111], v[110:111], v[112:113]
v_pk_add_f32 v[96:97], v[96:97], v[104:105]
s_waitcnt lgkmcnt(4)
v_mfma_f32_32x32x16_bf16 v[64:79], v[176:179], a[124:127], v[64:79]
ds_read_b128 v[172:175], v228 offset:51200
v_pk_add_f32 v[106:107], v[106:107], v[114:115]
v_pk_add_f32 v[96:97], v[96:97], v[100:101]
v_pk_add_f32 v[106:107], v[106:107], v[110:111]
v_add_f32 v196, v96, v97
s_waitcnt lgkmcnt(4)
v_mfma_f32_32x32x16_bf16 v[64:79], v[180:183], a[128:131], v[64:79]
ds_read_b128 v[176:179], v228 offset:54272
v_add_f32 v198, v106, v107
v_rcp_f32 v196, v196
v_rcp_f32 v198, v198
v_pk_mul_f32 v[128:129], v[128:129], v[196:197] op_sel_hi:[1,0]
buffer_load_dwordx4 a[248:251], v3, s[8:11], s56 offen offset:0 sc1
s_waitcnt lgkmcnt(4)
v_mfma_f32_32x32x16_bf16 v[64:79], v[184:187], a[132:135], v[64:79]
ds_read_b128 v[180:183], v228 offset:57344
v_pk_mul_f32 v[130:131], v[130:131], v[196:197] op_sel_hi:[1,0]
v_pk_mul_f32 v[132:133], v[132:133], v[196:197] op_sel_hi:[1,0]
v_pk_mul_f32 v[134:135], v[134:135], v[196:197] op_sel_hi:[1,0]
v_cvt_pk_bf16_f32 v96, v128, v129
s_waitcnt lgkmcnt(4)
v_mfma_f32_32x32x16_bf16 v[64:79], v[188:191], a[136:139], v[64:79]
ds_read_b128 v[184:187], v228 offset:60416
v_pk_mul_f32 v[136:137], v[136:137], v[196:197] op_sel_hi:[1,0]
v_cvt_pk_bf16_f32 v97, v130, v131
v_pk_mul_f32 v[138:139], v[138:139], v[196:197] op_sel_hi:[1,0]
v_cvt_pk_bf16_f32 v98, v132, v133
s_waitcnt lgkmcnt(4)
v_mfma_f32_32x32x16_bf16 v[64:79], v[168:171], a[140:143], v[64:79]
v_pk_mul_f32 v[140:141], v[140:141], v[196:197] op_sel_hi:[1,0]
v_cvt_pk_bf16_f32 v99, v134, v135
v_pk_mul_f32 v[142:143], v[142:143], v[196:197] op_sel_hi:[1,0]
buffer_load_dwordx4 a[252:255], v3, s[8:11], s57 offen offset:0 sc1
v_cvt_pk_bf16_f32 v100, v136, v137
s_waitcnt lgkmcnt(3)
v_mfma_f32_32x32x16_bf16 v[64:79], v[172:175], a[144:147], v[64:79]
v_pk_mul_f32 v[144:145], v[144:145], v[196:197] op_sel_hi:[1,0]
v_cvt_pk_bf16_f32 v101, v138, v139
v_pk_mul_f32 v[146:147], v[146:147], v[196:197] op_sel_hi:[1,0]
v_cvt_pk_bf16_f32 v102, v140, v141
s_waitcnt lgkmcnt(2)
v_mfma_f32_32x32x16_bf16 v[64:79], v[176:179], a[148:151], v[64:79]
v_pk_mul_f32 v[148:149], v[148:149], v[198:199] op_sel_hi:[1,0]
v_cvt_pk_bf16_f32 v103, v142, v143
v_pk_mul_f32 v[150:151], v[150:151], v[198:199] op_sel_hi:[1,0]
v_cvt_pk_bf16_f32 v104, v144, v145
s_waitcnt lgkmcnt(1)
v_mfma_f32_32x32x16_bf16 v[64:79], v[180:183], a[152:155], v[64:79]
v_pk_mul_f32 v[152:153], v[152:153], v[198:199] op_sel_hi:[1,0]
buffer_load_dwordx4 v[240:243], v3, s[8:11], s58 offen offset:0 sc1
v_cvt_pk_bf16_f32 v105, v146, v147
v_pk_mul_f32 v[154:155], v[154:155], v[198:199] op_sel_hi:[1,0]
v_cvt_pk_bf16_f32 v106, v148, v149
s_waitcnt lgkmcnt(0)
v_mfma_f32_32x32x16_bf16 v[64:79], v[184:187], a[156:159], v[64:79]
v_pk_mul_f32 v[156:157], v[156:157], v[198:199] op_sel_hi:[1,0]
v_cvt_pk_bf16_f32 v107, v150, v151
v_pk_mul_f32 v[158:159], v[158:159], v[198:199] op_sel_hi:[1,0]
v_cvt_pk_bf16_f32 v108, v152, v153
v_mfma_f32_32x32x16_bf16 v[64:79], v[24:27], v[12:15], v[64:79]
v_pk_mul_f32 v[160:161], v[160:161], v[198:199] op_sel_hi:[1,0]
v_cvt_pk_bf16_f32 v109, v154, v155
v_pk_mul_f32 v[162:163], v[162:163], v[198:199] op_sel_hi:[1,0]
v_cvt_pk_bf16_f32 v110, v156, v157
v_pk_mul_f32 v[164:165], v[164:165], v[198:199] op_sel_hi:[1,0]
v_cvt_pk_bf16_f32 v111, v158, v159
v_pk_mul_f32 v[166:167], v[166:167], v[198:199] op_sel_hi:[1,0]
v_cvt_pk_bf16_f32 v112, v160, v161
v_cvt_pk_bf16_f32 v113, v162, v163
v_cvt_pk_bf16_f32 v114, v164, v165
v_cvt_pk_bf16_f32 v115, v166, v167
mn_a1j:
v_pk_mul_f32 v[52:53], v[52:53], v[10:11] op_sel_hi:[1,0]
v_pk_mul_f32 v[54:55], v[54:55], v[10:11] op_sel_hi:[1,0]
v_pk_mul_f32 v[56:57], v[56:57], v[10:11] op_sel_hi:[1,0]
v_pk_mul_f32 v[58:59], v[58:59], v[10:11] op_sel_hi:[1,0]
v_pk_mul_f32 v[60:61], v[60:61], v[10:11] op_sel_hi:[1,0]
v_pk_mul_f32 v[62:63], v[62:63], v[10:11] op_sel_hi:[1,0]
v_pk_mul_f32 v[64:65], v[64:65], v[10:11] op_sel_hi:[1,0]
v_pk_mul_f32 v[66:67], v[66:67], v[10:11] op_sel_hi:[1,0]
v_pk_mul_f32 v[68:69], v[68:69], v[10:11] op_sel_hi:[1,0]
v_pk_mul_f32 v[70:71], v[70:71], v[10:11] op_sel_hi:[1,0]
v_cvt_pk_bf16_f32 v116, v52, v53
v_cvt_pk_bf16_f32 v117, v54, v55
v_cvt_pk_bf16_f32 v118, v56, v57
v_cvt_pk_bf16_f32 v119, v58, v59
v_cvt_pk_bf16_f32 v120, v60, v61
v_cvt_pk_bf16_f32 v121, v62, v63
v_cvt_pk_bf16_f32 v122, v64, v65
v_cvt_pk_bf16_f32 v123, v66, v67
v_cvt_pk_bf16_f32 v124, v68, v69
v_cvt_pk_bf16_f32 v125, v70, v71
v_mov_b32 v126, 0x3f80
v_mov_b32 v127, 0
s_barrier
ds_write_b128 v200, v[96:99] offset:0
s_add_u32 m0, s50, 0
s_add_u32 s53, s48, 0
buffer_load_dwordx4 v230, s[60:63], s53 offen offset:0 lds
ds_write_b128 v200, v[100:103] offset:16
ds_write_b128 v200, v[104:107] offset:32
ds_write_b128 v200, v[108:111] offset:48
ds_write_b128 v200, v[112:115] offset:64
buffer_load_dwordx4 v231, s[60:63], s53 offen offset:1024 lds
ds_write_b128 v200, v[116:119] offset:80
ds_write_b128 v200, v[120:123] offset:96
ds_write_b128 v200, v[124:127] offset:112
s_lshl_b32 s3, s37, 4
s_sub_u32 s3, s3, 8
v_add_u32 v203, s3, v4
v_cmp_gt_u32 s[38:39], 21, v203
v_mul_u32_u24 v203, 80, v203
v_lshl_add_u32 v203, v5, 3, v203
s_mul_i32 s3, s36, 1680
v_add_u32 v203, s3, v203
s_lshl_b32 s6, s22, 4
s_add_u32 s7, s6, s21
s_mul_i32 s7, s7, 3584
s_add_u32 s7, s7, s27
s_add_u32 s7, s7, 11403264
s_mul_i32 s6, s6, 3584
s_add_u32 s6, s6, s27
s_add_u32 s6, s6, 11403264
buffer_load_dwordx4 v232, s[60:63], s53 offen offset:2048 lds
buffer_load_dwordx4 v233, s[60:63], s53 offen offset:3072 lds
s_waitcnt lgkmcnt(0)
s_barrier
ds_read_b64_tr_b16 v[128:129], v201 offset:0
ds_read_b64_tr_b16 v[130:131], v201 offset:2560
ds_read_b64_tr_b16 v[132:133], v201 offset:32
ds_read_b64_tr_b16 v[134:135], v201 offset:2592
ds_read_b64_tr_b16 v[136:137], v201 offset:64
ds_read_b64_tr_b16 v[138:139], v201 offset:2624
ds_read_b64_tr_b16 v[140:141], v202 offset:0
ds_read_b64_tr_b16 v[142:143], v202 offset:2560
s_add_u32 m0, s50, 4096
s_add_u32 s53, s48, 98304
buffer_load_dwordx4 v230, s[60:63], s53 offen offset:0 lds
ds_read_b64_tr_b16 v[144:145], v201 offset:5120
ds_read_b64_tr_b16 v[146:147], v201 offset:7680
ds_read_b64_tr_b16 v[148:149], v201 offset:5152
ds_read_b64_tr_b16 v[150:151], v201 offset:7712
ds_read_b64_tr_b16 v[152:153], v201 offset:5184
ds_read_b64_tr_b16 v[154:155], v201 offset:7744
ds_read_b64_tr_b16 v[156:157], v202 offset:5120
ds_read_b64_tr_b16 v[158:159], v202 offset:7680
s_waitcnt lgkmcnt(8)
v_mfma_f32_16x16x32_bf16 v[192:195], v[128:131], v[140:143], 0
v_mfma_f32_16x16x32_bf16 v[196:199], v[132:135], v[140:143], 0
v_mfma_f32_16x16x32_bf16 v[204:207], v[136:139], v[140:143], 0
buffer_load_dwordx4 v231, s[60:63], s53 offen offset:1024 lds
ds_read_b64_tr_b16 v[160:161], v201 offset:10240
ds_read_b64_tr_b16 v[162:163], v201 offset:12800
ds_read_b64_tr_b16 v[164:165], v201 offset:10272
ds_read_b64_tr_b16 v[166:167], v201 offset:12832
ds_read_b64_tr_b16 v[168:169], v201 offset:10304
ds_read_b64_tr_b16 v[170:171], v201 offset:12864
ds_read_b64_tr_b16 v[172:173], v202 offset:10240
ds_read_b64_tr_b16 v[174:175], v202 offset:12800
s_waitcnt lgkmcnt(8)
v_mfma_f32_16x16x32_bf16 v[192:195], v[144:147], v[156:159], v[192:195]
v_mfma_f32_16x16x32_bf16 v[196:199], v[148:151], v[156:159], v[196:199]
v_mfma_f32_16x16x32_bf16 v[204:207], v[152:155], v[156:159], v[204:207]
buffer_load_dwordx4 v232, s[60:63], s53 offen offset:2048 lds
ds_read_b64_tr_b16 v[176:177], v201 offset:15360
ds_read_b64_tr_b16 v[178:179], v201 offset:17920
ds_read_b64_tr_b16 v[180:181], v201 offset:15392
ds_read_b64_tr_b16 v[182:183], v201 offset:17952
ds_read_b64_tr_b16 v[184:185], v201 offset:15424
ds_read_b64_tr_b16 v[186:187], v201 offset:17984
ds_read_b64_tr_b16 v[188:189], v202 offset:15360
ds_read_b64_tr_b16 v[190:191], v202 offset:17920
s_waitcnt lgkmcnt(8)
v_mfma_f32_16x16x32_bf16 v[192:195], v[160:163], v[172:175], v[192:195]
v_mfma_f32_16x16x32_bf16 v[196:199], v[164:167], v[172:175], v[196:199]
v_mfma_f32_16x16x32_bf16 v[204:207], v[168:171], v[172:175], v[204:207]
buffer_load_dwordx4 v233, s[60:63], s53 offen offset:3072 lds
s_waitcnt lgkmcnt(0)
v_mfma_f32_16x16x32_bf16 v[192:195], v[176:179], v[188:191], v[192:195]
v_mfma_f32_16x16x32_bf16 v[196:199], v[180:183], v[188:191], v[196:199]
v_mfma_f32_16x16x32_bf16 v[204:207], v[184:187], v[188:191], v[204:207]
ds_read_b128 v[96:99], v229 offset:0
ds_read_b128 v[100:103], v229 offset:1024
ds_read_b128 v[104:107], v229 offset:2048
ds_read_b128 v[108:111], v229 offset:3072
ds_read_b128 v[112:115], v229 offset:4096
ds_read_b128 v[116:119], v229 offset:5120
ds_read_b128 v[120:123], v229 offset:6144
ds_read_b128 v[124:127], v229 offset:7168
v_cvt_pk_bf16_f32 v192, v192, v193
v_cvt_pk_bf16_f32 v193, v194, v195
v_cvt_pk_bf16_f32 v196, v196, v197
v_cvt_pk_bf16_f32 v197, v198, v199
v_cvt_pk_bf16_f32 v204, v204, v205
v_cvt_pk_bf16_f32 v205, v206, v207
s_mov_b64 exec, s[38:39]
buffer_store_dwordx2 v[192:193], v203, s[8:11], s7 offen sc1
buffer_store_dwordx2 v[196:197], v203, s[8:11], s7 offen offset:32 sc1
s_mov_b32 exec_hi, 0
buffer_store_dwordx2 v[204:205], v203, s[8:11], s7 offen offset:64 sc1
s_mov_b64 exec, -1
ds_read_b128 v[128:131], v229 offset:8192
ds_read_b128 v[132:135], v229 offset:9216
ds_read_b128 v[136:139], v229 offset:10240
ds_read_b128 v[140:143], v229 offset:11264
v_mfma_f32_32x32x16_bf16 v[80:95], v[28:31], v[12:15], 0
s_waitcnt lgkmcnt(11)
v_mfma_f32_32x32x16_bf16 v[80:95], v[96:99], a[0:3], v[80:95]
ds_read_b128 v[144:147], v229 offset:12288
s_waitcnt lgkmcnt(11)
v_mfma_f32_32x32x16_bf16 v[80:95], v[100:103], a[4:7], v[80:95]
ds_read_b128 v[148:151], v229 offset:13312
s_add_u32 m0, s50, 8192
s_add_u32 s53, s48, 196608
buffer_load_dwordx4 v230, s[60:63], s53 offen offset:0 lds
s_waitcnt lgkmcnt(11)
v_mfma_f32_32x32x16_bf16 v[80:95], v[104:107], a[8:11], v[80:95]
ds_read_b128 v[96:99], v229 offset:14336
v_lshrrev_b32 v200, 3, v6
s_waitcnt lgkmcnt(11)
v_mfma_f32_32x32x16_bf16 v[80:95], v[108:111], a[12:15], v[80:95]
ds_read_b128 v[100:103], v229 offset:15360
v_and_b32 v201, 3, v6
s_waitcnt lgkmcnt(11)
v_mfma_f32_32x32x16_bf16 v[80:95], v[112:115], a[16:19], v[80:95]
ds_read_b128 v[104:107], v229 offset:16384
v_lshl_add_u32 v200, v200, 2, v201
buffer_load_dwordx4 v231, s[60:63], s53 offen offset:1024 lds
s_waitcnt lgkmcnt(11)
v_mfma_f32_32x32x16_bf16 v[80:95], v[116:119], a[20:23], v[80:95]
ds_read_b128 v[108:111], v229 offset:17408
v_bfe_u32 v201, v6, 2, 1
s_waitcnt lgkmcnt(11)
v_mfma_f32_32x32x16_bf16 v[80:95], v[120:123], a[24:27], v[80:95]
ds_read_b128 v[112:115], v229 offset:18432
v_cmp_eq_u32 vcc, v201, v7
s_waitcnt lgkmcnt(11)
v_mfma_f32_32x32x16_bf16 v[80:95], v[124:127], a[28:31], v[80:95]
ds_read_b128 v[116:119], v229 offset:19456
v_cmp_gt_u32 s[38:39], 5, v200
buffer_load_dwordx4 v232, s[60:63], s53 offen offset:2048 lds
s_waitcnt lgkmcnt(11)
v_mfma_f32_32x32x16_bf16 v[80:95], v[128:131], a[32:35], v[80:95]
ds_read_b128 v[120:123], v229 offset:20480
v_mul_u32_u24 v200, 80, v200
s_waitcnt lgkmcnt(11)
v_mfma_f32_32x32x16_bf16 v[80:95], v[132:135], a[36:39], v[80:95]
ds_read_b128 v[124:127], v229 offset:21504
v_mul_u32_u24 v201, 1680, v201
s_waitcnt lgkmcnt(11)
v_mfma_f32_32x32x16_bf16 v[80:95], v[136:139], a[40:43], v[80:95]
ds_read_b128 v[128:131], v229 offset:22528
v_add_u32 v200, v200, v201
buffer_load_dwordx4 v233, s[60:63], s53 offen offset:3072 lds
s_waitcnt lgkmcnt(11)
v_mfma_f32_32x32x16_bf16 v[80:95], v[140:143], a[44:47], v[80:95]
ds_read_b128 v[132:135], v229 offset:23552
v_add_u32 v201, 1280, v200
s_waitcnt lgkmcnt(11)
v_mfma_f32_32x32x16_bf16 v[80:95], v[144:147], a[48:51], v[80:95]
ds_read_b128 v[136:139], v229 offset:24576
v_mov_b32 v202, 3360
s_waitcnt lgkmcnt(11)
v_mfma_f32_32x32x16_bf16 v[80:95], v[148:151], a[52:55], v[80:95]
ds_read_b128 v[140:143], v229 offset:25600
s_and_b64 s[38:39], s[38:39], vcc
s_add_u32 m0, s50, 12288
s_add_u32 s53, s48, 294912
buffer_load_dwordx4 v230, s[60:63], s53 offen offset:0 lds
s_waitcnt lgkmcnt(11)
v_mfma_f32_32x32x16_bf16 v[80:95], v[96:99], a[56:59], v[80:95]
ds_read_b128 v[144:147], v229 offset:26624
v_cndmask_b32 v200, v202, v200, vcc
s_waitcnt lgkmcnt(11)
v_mfma_f32_32x32x16_bf16 v[80:95], v[100:103], a[60:63], v[80:95]
ds_read_b128 v[148:151], v229 offset:27648
v_cndmask_b32 v201, v202, v201, s[38:39]
s_waitcnt lgkmcnt(11)
v_mfma_f32_32x32x16_bf16 v[80:95], v[104:107], a[64:67], v[80:95]
ds_read_b128 v[96:99], v229 offset:28672
v_lshlrev_b32 v203, 4, v0
buffer_load_dwordx4 v231, s[60:63], s53 offen offset:1024 lds
s_waitcnt lgkmcnt(11)
v_mfma_f32_32x32x16_bf16 v[80:95], v[108:111], a[68:71], v[80:95]
ds_read_b128 v[100:103], v229 offset:29696
v_cmp_gt_u32 vcc, 210, v0
s_waitcnt lgkmcnt(11)
v_mfma_f32_32x32x16_bf16 v[80:95], v[112:115], a[72:75], v[80:95]
ds_read_b128 v[104:107], v229 offset:30720
v_mov_b32 v202, 0x40000000
s_waitcnt lgkmcnt(11)
v_mfma_f32_32x32x16_bf16 v[80:95], v[116:119], a[76:79], v[80:95]
ds_read_b128 v[108:111], v229 offset:31744
v_cndmask_b32 v204, v202, v203, vcc
buffer_load_dwordx4 v232, s[60:63], s53 offen offset:2048 lds
s_waitcnt lgkmcnt(11)
v_mfma_f32_32x32x16_bf16 v[80:95], v[120:123], a[80:83], v[80:95]
ds_read_b128 v[112:115], v229 offset:32768
v_lshrrev_b32 v206, 4, v6
s_waitcnt lgkmcnt(11)
v_mfma_f32_32x32x16_bf16 v[80:95], v[124:127], a[84:87], v[80:95]
ds_read_b128 v[116:119], v229 offset:33792
v_mul_u32_u24 v206, 20480, v206
s_waitcnt lgkmcnt(11)
v_mfma_f32_32x32x16_bf16 v[80:95], v[128:131], a[88:91], v[80:95]
ds_read_b128 v[120:123], v229 offset:34816
v_and_b32 v207, 15, v6
buffer_load_dwordx4 v233, s[60:63], s53 offen offset:3072 lds
s_waitcnt lgkmcnt(11)
v_mfma_f32_32x32x16_bf16 v[80:95], v[132:135], a[92:95], v[80:95]
ds_read_b128 v[124:127], v229 offset:35840
v_lshl_add_u32 v206, v207, 4, v206
s_waitcnt lgkmcnt(11)
v_mfma_f32_32x32x16_bf16 v[80:95], v[136:139], a[96:99], v[80:95]
ds_read_b128 v[128:131], v229 offset:36864
v_lshl_add_u32 v207, v7, 3, v206
s_waitcnt lgkmcnt(11)
v_mfma_f32_32x32x16_bf16 v[80:95], v[140:143], a[100:103], v[80:95]
ds_read_b128 v[132:135], v229 offset:37888
v_lshl_add_u32 v206, v7, 9, v206
s_add_u32 m0, s50, 16384
s_add_u32 s53, s48, 393216
buffer_load_dwordx4 v230, s[60:63], s53 offen offset:0 lds
s_waitcnt lgkmcnt(11)
v_mfma_f32_32x32x16_bf16 v[80:95], v[144:147], a[104:107], v[80:95]
ds_read_b128 v[136:139], v229 offset:38912
s_lshl_b32 s3, s21, 2
s_add_u32 s3, s3, s20
s_mul_i32 s3, s3, 40960
s_mul_i32 s4, s22, 1280
s_add_u32 s3, s3, s4
s_add_u32 s3, s3, s27
s_add_u32 s33, s3, 2621440
s_waitcnt lgkmcnt(11)
v_mfma_f32_32x32x16_bf16 v[80:95], v[148:151], a[108:111], v[80:95]
ds_read_b128 v[140:143], v229 offset:39936
s_lshr_b32 s57, s2, 3
s_mul_i32 s57, s57, 33792
s_mul_i32 s4, s20, 1572864
s_add_u32 s57, s57, s4
s_bfe_u32 s4, s2, 0x20001
s_min_u32 s5, s4, 2
s_lshl_b32 s5, s5, 10
s_add_u32 s57, s57, s5
s_add_u32 s57, s57, 491904
s_cmp_eq_u32 s4, 2
s_cselect_b32 s4, 0, 11
s_waitcnt lgkmcnt(11)
v_mfma_f32_32x32x16_bf16 v[80:95], v[96:99], a[112:115], v[80:95]
v_mul_u32_u24 v12, 3072, v1
v_cmp_gt_u32 vcc, s4, v1
s_nop 1
v_cndmask_b32 v12, v254, v12, vcc
buffer_load_dwordx4 v231, s[60:63], s53 offen offset:1024 lds
s_waitcnt lgkmcnt(10)
v_mfma_f32_32x32x16_bf16 v[80:95], v[100:103], a[116:119], v[80:95]
s_lshr_b32 s58, s2, 3
s_mul_i32 s58, s58, 24576
s_mul_i32 s4, s20, 1572864
s_add_u32 s58, s58, s4
s_and_b32 s4, s23, 24
s_lshl_b32 s4, s4, 7
s_add_u32 s58, s58, s4
s_add_u32 s58, s58, 384
s_waitcnt lgkmcnt(9)
v_mfma_f32_32x32x16_bf16 v[80:95], v[104:107], a[120:123], v[80:95]
v_lshlrev_b32 v9, 12, v1
v_cmp_le_u32 vcc, 6, v1
v_add_u32 v11, -24064, v9
s_nop 0
v_cndmask_b32 v9, v9, v11, vcc
v_cmp_gt_u32 vcc, 6, v1
v_mov_b32 v11, 0x40000000
s_nop 0
v_cndmask_b32 v9, v11, v9, vcc
s_waitcnt lgkmcnt(8)
v_mfma_f32_32x32x16_bf16 v[80:95], v[108:111], a[124:127], v[80:95]
buffer_load_dwordx4 v232, s[60:63], s53 offen offset:2048 lds
s_waitcnt lgkmcnt(7)
v_mfma_f32_32x32x16_bf16 v[80:95], v[112:115], a[128:131], v[80:95]
s_waitcnt lgkmcnt(6)
v_mfma_f32_32x32x16_bf16 v[80:95], v[116:119], a[132:135], v[80:95]
s_waitcnt lgkmcnt(5)
v_mfma_f32_32x32x16_bf16 v[80:95], v[120:123], a[136:139], v[80:95]
buffer_load_dwordx4 v233, s[60:63], s53 offen offset:3072 lds
s_waitcnt lgkmcnt(4)
v_mfma_f32_32x32x16_bf16 v[80:95], v[124:127], a[140:143], v[80:95]
s_waitcnt lgkmcnt(3)
v_mfma_f32_32x32x16_bf16 v[80:95], v[128:131], a[144:147], v[80:95]
s_waitcnt lgkmcnt(2)
v_mfma_f32_32x32x16_bf16 v[80:95], v[132:135], a[148:151], v[80:95]
s_waitcnt lgkmcnt(1)
v_mfma_f32_32x32x16_bf16 v[80:95], v[136:139], a[152:155], v[80:95]
s_waitcnt lgkmcnt(0)
v_mfma_f32_32x32x16_bf16 v[80:95], v[140:143], a[156:159], v[80:95]
v_max3_f32 v128, v72, v73, v74
s_add_u32 s35, s6, 0
buffer_load_dwordx4 v[16:19], v204, s[8:11], s35 offen sc1
v_min3_f32 v136, v72, v73, v74
v_max3_f32 v129, v75, v76, v77
v_min3_f32 v137, v75, v76, v77
s_nop 5
v_max3_f32 v130, v78, v79, v80
v_min3_f32 v138, v78, v79, v80
v_max3_f32 v131, v81, v82, v83
v_min3_f32 v139, v81, v82, v83
v_max3_f32 v132, v84, v85, v86
v_min3_f32 v140, v84, v85, v86
s_add_u32 s35, s6, 3584
buffer_load_dwordx4 v[20:23], v204, s[8:11], s35 offen sc1
v_max3_f32 v133, v87, v88, v89
v_min3_f32 v141, v87, v88, v89
v_max3_f32 v128, v128, v90, v91
v_min3_f32 v136, v136, v90, v91
v_max3_f32 v129, v129, v130, v131
v_min3_f32 v137, v137, v138, v139
v_max3_f32 v128, v128, v132, v133
v_min3_f32 v136, v136, v140, v141
v_max_f32 v128, v128, v129
s_add_u32 s35, s6, 7168
buffer_load_dwordx4 v[24:27], v204, s[8:11], s35 offen sc1
v_min_f32 v136, v136, v137
v_mul_f32 v194, v128, -v8
v_mul_f32 v196, v136, v8
v_pk_fma_f32 v[128:129], v[72:73], v[8:9], v[194:195] op_sel_hi:[1,0,0]
v_pk_fma_f32 v[148:149], v[72:73], v[8:9], v[196:197] op_sel_hi:[1,0,0] neg_lo:[1,0,0] neg_hi:[1,0,0]
v_pk_fma_f32 v[130:131], v[74:75], v[8:9], v[194:195] op_sel_hi:[1,0,0]
v_pk_fma_f32 v[150:151], v[74:75], v[8:9], v[196:197] op_sel_hi:[1,0,0] neg_lo:[1,0,0] neg_hi:[1,0,0]
v_exp_f32 v128, v128
v_exp_f32 v129, v129
s_add_u32 s35, s6, 10752
buffer_load_dwordx4 v[28:31], v204, s[8:11], s35 offen sc1
v_pk_fma_f32 v[132:133], v[76:77], v[8:9], v[194:195] op_sel_hi:[1,0,0]
v_exp_f32 v148, v148
v_exp_f32 v149, v149
v_pk_fma_f32 v[152:153], v[76:77], v[8:9], v[196:197] op_sel_hi:[1,0,0] neg_lo:[1,0,0] neg_hi:[1,0,0]
v_exp_f32 v130, v130
v_exp_f32 v131, v131
v_pk_fma_f32 v[134:135], v[78:79], v[8:9], v[194:195] op_sel_hi:[1,0,0]
v_exp_f32 v150, v150
v_exp_f32 v151, v151
s_add_u32 s35, s6, 14336
buffer_load_dwordx4 v[32:35], v204, s[8:11], s35 offen sc1
v_pk_fma_f32 v[154:155], v[78:79], v[8:9], v[196:197] op_sel_hi:[1,0,0] neg_lo:[1,0,0] neg_hi:[1,0,0]
v_exp_f32 v132, v132
v_exp_f32 v133, v133
v_pk_fma_f32 v[136:137], v[80:81], v[8:9], v[194:195] op_sel_hi:[1,0,0]
v_exp_f32 v152, v152
v_exp_f32 v153, v153
v_pk_fma_f32 v[156:157], v[80:81], v[8:9], v[196:197] op_sel_hi:[1,0,0] neg_lo:[1,0,0] neg_hi:[1,0,0]
v_exp_f32 v134, v134
v_exp_f32 v135, v135
s_add_u32 s35, s6, 17920
buffer_load_dwordx4 v[36:39], v204, s[8:11], s35 offen sc1
v_pk_fma_f32 v[138:139], v[82:83], v[8:9], v[194:195] op_sel_hi:[1,0,0]
v_exp_f32 v154, v154
v_exp_f32 v155, v155
v_pk_fma_f32 v[158:159], v[82:83], v[8:9], v[196:197] op_sel_hi:[1,0,0] neg_lo:[1,0,0] neg_hi:[1,0,0]
v_exp_f32 v136, v136
v_exp_f32 v137, v137
v_pk_fma_f32 v[140:141], v[84:85], v[8:9], v[194:195] op_sel_hi:[1,0,0]
v_exp_f32 v156, v156
v_exp_f32 v157, v157
s_add_u32 s35, s6, 21504
buffer_load_dwordx4 v[40:43], v204, s[8:11], s35 offen sc1
v_pk_fma_f32 v[160:161], v[84:85], v[8:9], v[196:197] op_sel_hi:[1,0,0] neg_lo:[1,0,0] neg_hi:[1,0,0]
v_exp_f32 v138, v138
v_exp_f32 v139, v139
v_pk_fma_f32 v[142:143], v[86:87], v[8:9], v[194:195] op_sel_hi:[1,0,0]
v_exp_f32 v158, v158
v_exp_f32 v159, v159
v_pk_fma_f32 v[162:163], v[86:87], v[8:9], v[196:197] op_sel_hi:[1,0,0] neg_lo:[1,0,0] neg_hi:[1,0,0]
v_exp_f32 v140, v140
v_exp_f32 v141, v141
s_add_u32 s35, s6, 25088
buffer_load_dwordx4 v[44:47], v204, s[8:11], s35 offen sc1
v_pk_fma_f32 v[144:145], v[88:89], v[8:9], v[194:195] op_sel_hi:[1,0,0]
v_exp_f32 v160, v160
v_exp_f32 v161, v161
v_pk_fma_f32 v[164:165], v[88:89], v[8:9], v[196:197] op_sel_hi:[1,0,0] neg_lo:[1,0,0] neg_hi:[1,0,0]
v_exp_f32 v142, v142
v_exp_f32 v143, v143
v_pk_fma_f32 v[146:147], v[90:91], v[8:9], v[194:195] op_sel_hi:[1,0,0]
v_exp_f32 v162, v162
v_exp_f32 v163, v163
s_add_u32 s35, s6, 28672
buffer_load_dwordx4 v[48:51], v204, s[8:11], s35 offen sc1
v_pk_fma_f32 v[166:167], v[90:91], v[8:9], v[196:197] op_sel_hi:[1,0,0] neg_lo:[1,0,0] neg_hi:[1,0,0]
v_exp_f32 v144, v144
v_exp_f32 v145, v145
v_exp_f32 v164, v164
v_exp_f32 v165, v165
v_exp_f32 v146, v146
v_exp_f32 v147, v147
v_exp_f32 v166, v166
v_exp_f32 v167, v167
s_add_u32 s35, s6, 32256
buffer_load_dwordx4 v[52:55], v204, s[8:11], s35 offen sc1
v_pk_add_f32 v[96:97], v[128:129], v[130:131]
v_pk_add_f32 v[106:107], v[148:149], v[150:151]
v_pk_add_f32 v[98:99], v[132:133], v[134:135]
v_pk_add_f32 v[108:109], v[152:153], v[154:155]
v_pk_add_f32 v[100:101], v[136:137], v[138:139]
v_pk_add_f32 v[110:111], v[156:157], v[158:159]
v_pk_add_f32 v[102:103], v[140:141], v[142:143]
v_pk_add_f32 v[112:113], v[160:161], v[162:163]
v_pk_add_f32 v[104:105], v[144:145], v[146:147]
s_add_u32 s35, s6, 35840
buffer_load_dwordx4 v[56:59], v204, s[8:11], s35 offen sc1
v_pk_add_f32 v[114:115], v[164:165], v[166:167]
v_pk_add_f32 v[96:97], v[96:97], v[98:99]
v_pk_add_f32 v[106:107], v[106:107], v[108:109]
v_pk_add_f32 v[100:101], v[100:101], v[102:103]
v_pk_add_f32 v[110:111], v[110:111], v[112:113]
v_pk_add_f32 v[96:97], v[96:97], v[104:105]
v_pk_add_f32 v[106:107], v[106:107], v[114:115]
v_pk_add_f32 v[96:97], v[96:97], v[100:101]
v_pk_add_f32 v[106:107], v[106:107], v[110:111]
s_add_u32 s35, s6, 39424
buffer_load_dwordx4 v[60:63], v204, s[8:11], s35 offen sc1
v_add_f32 v196, v96, v97
v_add_f32 v198, v106, v107
v_rcp_f32 v196, v196
v_rcp_f32 v198, v198
v_pk_mul_f32 v[128:129], v[128:129], v[196:197] op_sel_hi:[1,0]
v_pk_mul_f32 v[130:131], v[130:131], v[196:197] op_sel_hi:[1,0]
v_pk_mul_f32 v[132:133], v[132:133], v[196:197] op_sel_hi:[1,0]
v_pk_mul_f32 v[134:135], v[134:135], v[196:197] op_sel_hi:[1,0]
v_cvt_pk_bf16_f32 v96, v128, v129
s_add_u32 s35, s6, 43008
buffer_load_dwordx4 v[64:67], v204, s[8:11], s35 offen sc1
v_pk_mul_f32 v[136:137], v[136:137], v[196:197] op_sel_hi:[1,0]
v_cvt_pk_bf16_f32 v97, v130, v131
v_pk_mul_f32 v[138:139], v[138:139], v[196:197] op_sel_hi:[1,0]
v_cvt_pk_bf16_f32 v98, v132, v133
v_pk_mul_f32 v[140:141], v[140:141], v[196:197] op_sel_hi:[1,0]
v_cvt_pk_bf16_f32 v99, v134, v135
v_pk_mul_f32 v[142:143], v[142:143], v[196:197] op_sel_hi:[1,0]
v_cvt_pk_bf16_f32 v100, v136, v137
v_pk_mul_f32 v[144:145], v[144:145], v[196:197] op_sel_hi:[1,0]
s_add_u32 s35, s6, 46592
buffer_load_dwordx4 v[68:71], v204, s[8:11], s35 offen sc1
v_cvt_pk_bf16_f32 v101, v138, v139
v_pk_mul_f32 v[146:147], v[146:147], v[196:197] op_sel_hi:[1,0]
v_cvt_pk_bf16_f32 v102, v140, v141
v_pk_mul_f32 v[148:149], v[148:149], v[198:199] op_sel_hi:[1,0]
v_cvt_pk_bf16_f32 v103, v142, v143
v_pk_mul_f32 v[150:151], v[150:151], v[198:199] op_sel_hi:[1,0]
v_cvt_pk_bf16_f32 v104, v144, v145
v_pk_mul_f32 v[152:153], v[152:153], v[198:199] op_sel_hi:[1,0]
v_cvt_pk_bf16_f32 v105, v146, v147
s_add_u32 s35, s6, 50176
buffer_load_dwordx4 v[168:171], v204, s[8:11], s35 offen sc1
v_pk_mul_f32 v[154:155], v[154:155], v[198:199] op_sel_hi:[1,0]
v_cvt_pk_bf16_f32 v106, v148, v149
v_pk_mul_f32 v[156:157], v[156:157], v[198:199] op_sel_hi:[1,0]
v_cvt_pk_bf16_f32 v107, v150, v151
v_pk_mul_f32 v[158:159], v[158:159], v[198:199] op_sel_hi:[1,0]
v_cvt_pk_bf16_f32 v108, v152, v153
v_pk_mul_f32 v[160:161], v[160:161], v[198:199] op_sel_hi:[1,0]
v_cvt_pk_bf16_f32 v109, v154, v155
v_pk_mul_f32 v[162:163], v[162:163], v[198:199] op_sel_hi:[1,0]
s_add_u32 s35, s6, 53760
buffer_load_dwordx4 v[172:175], v204, s[8:11], s35 offen sc1
v_cvt_pk_bf16_f32 v110, v156, v157
v_pk_mul_f32 v[164:165], v[164:165], v[198:199] op_sel_hi:[1,0]
v_cvt_pk_bf16_f32 v111, v158, v159
v_pk_mul_f32 v[166:167], v[166:167], v[198:199] op_sel_hi:[1,0]
v_cvt_pk_bf16_f32 v112, v160, v161
v_cvt_pk_bf16_f32 v113, v162, v163
v_cvt_pk_bf16_f32 v114, v164, v165
v_cvt_pk_bf16_f32 v115, v166, v167
s_mov_b32 s3, 0x3f80
s_mov_b32 s4, 0x3f800000
s_mov_b32 s5, 262144
mn_kvsum:
v_mov_b32 v176, 0
v_mov_b32 v177, 0
v_mov_b32 v178, 0
v_mov_b32 v179, 0
v_mov_b32 v180, 0
v_mov_b32 v181, 0
v_mov_b32 v182, 0
v_mov_b32 v183, 0
v_mov_b32 v184, 0
s_waitcnt vmcnt(14)
v_dot2c_f32_bf16 v176, s3, v16
v_dot2c_f32_bf16 v177, s4, v16
v_dot2c_f32_bf16 v178, s3, v17
v_dot2c_f32_bf16 v179, s4, v17
v_dot2c_f32_bf16 v180, s3, v18
v_dot2c_f32_bf16 v181, s4, v18
v_dot2c_f32_bf16 v182, s3, v19
v_dot2c_f32_bf16 v183, s4, v19
v_max3_u32 v184, v184, v16, v18
v_dot2c_f32_bf16 v176, s3, v20
v_dot2c_f32_bf16 v177, s4, v20
v_dot2c_f32_bf16 v178, s3, v21
v_dot2c_f32_bf16 v179, s4, v21
v_dot2c_f32_bf16 v180, s3, v22
v_dot2c_f32_bf16 v181, s4, v22
v_dot2c_f32_bf16 v182, s3, v23
v_dot2c_f32_bf16 v183, s4, v23
v_max3_u32 v184, v184, v20, v22
s_waitcnt vmcnt(12)
v_dot2c_f32_bf16 v176, s3, v24
v_dot2c_f32_bf16 v177, s4, v24
v_dot2c_f32_bf16 v178, s3, v25
v_dot2c_f32_bf16 v179, s4, v25
v_dot2c_f32_bf16 v180, s3, v26
v_dot2c_f32_bf16 v181, s4, v26
v_dot2c_f32_bf16 v182, s3, v27
v_dot2c_f32_bf16 v183, s4, v27
v_max3_u32 v184, v184, v24, v26
v_dot2c_f32_bf16 v176, s3, v28
v_dot2c_f32_bf16 v177, s4, v28
v_dot2c_f32_bf16 v178, s3, v29
v_dot2c_f32_bf16 v179, s4, v29
v_dot2c_f32_bf16 v180, s3, v30
v_dot2c_f32_bf16 v181, s4, v30
v_dot2c_f32_bf16 v182, s3, v31
v_dot2c_f32_bf16 v183, s4, v31
v_max3_u32 v184, v184, v28, v30
s_waitcnt vmcnt(10)
v_dot2c_f32_bf16 v176, s3, v32
v_dot2c_f32_bf16 v177, s4, v32
v_dot2c_f32_bf16 v178, s3, v33
v_dot2c_f32_bf16 v179, s4, v33
v_dot2c_f32_bf16 v180, s3, v34
v_dot2c_f32_bf16 v181, s4, v34
v_dot2c_f32_bf16 v182, s3, v35
v_dot2c_f32_bf16 v183, s4, v35
v_max3_u32 v184, v184, v32, v34
v_dot2c_f32_bf16 v176, s3, v36
v_dot2c_f32_bf16 v177, s4, v36
v_dot2c_f32_bf16 v178, s3, v37
v_dot2c_f32_bf16 v179, s4, v37
v_dot2c_f32_bf16 v180, s3, v38
v_dot2c_f32_bf16 v181, s4, v38
v_dot2c_f32_bf16 v182, s3, v39
v_dot2c_f32_bf16 v183, s4, v39
v_max3_u32 v184, v184, v36, v38
s_waitcnt vmcnt(8)
v_dot2c_f32_bf16 v176, s3, v40
v_dot2c_f32_bf16 v177, s4, v40
v_dot2c_f32_bf16 v178, s3, v41
v_dot2c_f32_bf16 v179, s4, v41
v_dot2c_f32_bf16 v180, s3, v42
v_dot2c_f32_bf16 v181, s4, v42
v_dot2c_f32_bf16 v182, s3, v43
v_dot2c_f32_bf16 v183, s4, v43
v_max3_u32 v184, v184, v40, v42
v_dot2c_f32_bf16 v176, s3, v44
v_dot2c_f32_bf16 v177, s4, v44
v_dot2c_f32_bf16 v178, s3, v45
v_dot2c_f32_bf16 v179, s4, v45
v_dot2c_f32_bf16 v180, s3, v46
v_dot2c_f32_bf16 v181, s4, v46
v_dot2c_f32_bf16 v182, s3, v47
v_dot2c_f32_bf16 v183, s4, v47
v_max3_u32 v184, v184, v44, v46
s_waitcnt vmcnt(6)
v_dot2c_f32_bf16 v176, s3, v48
v_dot2c_f32_bf16 v177, s4, v48
v_dot2c_f32_bf16 v178, s3, v49
v_dot2c_f32_bf16 v179, s4, v49
v_dot2c_f32_bf16 v180, s3, v50
v_dot2c_f32_bf16 v181, s4, v50
v_dot2c_f32_bf16 v182, s3, v51
v_dot2c_f32_bf16 v183, s4, v51
v_max3_u32 v184, v184, v48, v50
v_dot2c_f32_bf16 v176, s3, v52
v_dot2c_f32_bf16 v177, s4, v52
v_dot2c_f32_bf16 v178, s3, v53
v_dot2c_f32_bf16 v179, s4, v53
v_dot2c_f32_bf16 v180, s3, v54
v_dot2c_f32_bf16 v181, s4, v54
v_dot2c_f32_bf16 v182, s3, v55
v_dot2c_f32_bf16 v183, s4, v55
v_max3_u32 v184, v184, v52, v54
s_waitcnt vmcnt(4)
v_dot2c_f32_bf16 v176, s3, v56
v_dot2c_f32_bf16 v177, s4, v56
v_dot2c_f32_bf16 v178, s3, v57
v_dot2c_f32_bf16 v179, s4, v57
v_dot2c_f32_bf16 v180, s3, v58
v_dot2c_f32_bf16 v181, s4, v58
v_dot2c_f32_bf16 v182, s3, v59
v_dot2c_f32_bf16 v183, s4, v59
v_max3_u32 v184, v184, v56, v58
v_dot2c_f32_bf16 v176, s3, v60
v_dot2c_f32_bf16 v177, s4, v60
v_dot2c_f32_bf16 v178, s3, v61
v_dot2c_f32_bf16 v179, s4, v61
v_dot2c_f32_bf16 v180, s3, v62
v_dot2c_f32_bf16 v181, s4, v62
v_dot2c_f32_bf16 v182, s3, v63
v_dot2c_f32_bf16 v183, s4, v63
v_max3_u32 v184, v184, v60, v62
s_waitcnt vmcnt(2)
v_dot2c_f32_bf16 v176, s3, v64
v_dot2c_f32_bf16 v177, s4, v64
v_dot2c_f32_bf16 v178, s3, v65
v_dot2c_f32_bf16 v179, s4, v65
v_dot2c_f32_bf16 v180, s3, v66
v_dot2c_f32_bf16 v181, s4, v66
v_dot2c_f32_bf16 v182, s3, v67
v_dot2c_f32_bf16 v183, s4, v67
v_max3_u32 v184, v184, v64, v66
v_dot2c_f32_bf16 v176, s3, v68
v_dot2c_f32_bf16 v177, s4, v68
v_dot2c_f32_bf16 v178, s3, v69
v_dot2c_f32_bf16 v179, s4, v69
v_dot2c_f32_bf16 v180, s3, v70
v_dot2c_f32_bf16 v181, s4, v70
v_dot2c_f32_bf16 v182, s3, v71
v_dot2c_f32_bf16 v183, s4, v71
v_max3_u32 v184, v184, v68, v70
s_waitcnt vmcnt(0)
v_dot2c_f32_bf16 v176, s3, v168
v_dot2c_f32_bf16 v177, s4, v168
v_dot2c_f32_bf16 v178, s3, v169
v_dot2c_f32_bf16 v179, s4, v169
v_dot2c_f32_bf16 v180, s3, v170
v_dot2c_f32_bf16 v181, s4, v170
v_dot2c_f32_bf16 v182, s3, v171
v_dot2c_f32_bf16 v183, s4, v171
v_max3_u32 v184, v184, v168, v170
v_dot2c_f32_bf16 v176, s3, v172
v_dot2c_f32_bf16 v177, s4, v172
v_dot2c_f32_bf16 v178, s3, v173
v_dot2c_f32_bf16 v179, s4, v173
v_dot2c_f32_bf16 v180, s3, v174
v_dot2c_f32_bf16 v181, s4, v174
v_dot2c_f32_bf16 v182, s3, v175
v_dot2c_f32_bf16 v183, s4, v175
v_max3_u32 v184, v184, v172, v174
v_cmp_eq_u32 vcc, -1, v184
s_cbranch_vccz mn_kvok
s_sub_u32 s5, s5, 1
s_cbranch_scc1 mn_kvok
s_add_u32 s35, s6, 0
buffer_load_dwordx4 v[16:19], v204, s[8:11], s35 offen sc1
s_add_u32 s35, s6, 3584
buffer_load_dwordx4 v[20:23], v204, s[8:11], s35 offen sc1
s_add_u32 s35, s6, 7168
buffer_load_dwordx4 v[24:27], v204, s[8:11], s35 offen sc1
s_add_u32 s35, s6, 10752
buffer_load_dwordx4 v[28:31], v204, s[8:11], s35 offen sc1
s_add_u32 s35, s6, 14336
buffer_load_dwordx4 v[32:35], v204, s[8:11], s35 offen sc1
s_add_u32 s35, s6, 17920
buffer_load_dwordx4 v[36:39], v204, s[8:11], s35 offen sc1
s_add_u32 s35, s6, 21504
buffer_load_dwordx4 v[40:43], v204, s[8:11], s35 offen sc1
s_add_u32 s35, s6, 25088
buffer_load_dwordx4 v[44:47], v204, s[8:11], s35 offen sc1
s_add_u32 s35, s6, 28672
buffer_load_dwordx4 v[48:51], v204, s[8:11], s35 offen sc1
s_add_u32 s35, s6, 32256
buffer_load_dwordx4 v[52:55], v204, s[8:11], s35 offen sc1
s_add_u32 s35, s6, 35840
buffer_load_dwordx4 v[56:59], v204, s[8:11], s35 offen sc1
s_add_u32 s35, s6, 39424
buffer_load_dwordx4 v[60:63], v204, s[8:11], s35 offen sc1
s_add_u32 s35, s6, 43008
buffer_load_dwordx4 v[64:67], v204, s[8:11], s35 offen sc1
s_add_u32 s35, s6, 46592
buffer_load_dwordx4 v[68:71], v204, s[8:11], s35 offen sc1
s_add_u32 s35, s6, 50176
buffer_load_dwordx4 v[168:171], v204, s[8:11], s35 offen sc1
s_add_u32 s35, s6, 53760
buffer_load_dwordx4 v[172:175], v204, s[8:11], s35 offen sc1
s_waitcnt vmcnt(0)
s_branch mn_kvsum
mn_kvok:
v_cvt_pk_bf16_f32 v184, v176, v177
v_cvt_pk_bf16_f32 v185, v178, v179
v_cvt_pk_bf16_f32 v186, v180, v181
v_cvt_pk_bf16_f32 v187, v182, v183
ds_write_b128 v203, v[184:187]
s_lshl_b32 s3, s21, 4
s_add_u32 s3, s3, s22
s_lshl_b32 s3, s3, 7
s_add_u32 s3, s3, s27
s_add_u32 s6, s3, 12468224
s_waitcnt lgkmcnt(0)
s_barrier
ds_read_b128 v[128:131], v200 offset:0
ds_read_b128 v[132:135], v201 offset:0
ds_read_b128 v[136:139], v200 offset:16
ds_read_b128 v[140:143], v201 offset:16
ds_read_b128 v[144:147], v200 offset:32
ds_read_b128 v[148:151], v201 offset:32
ds_read_b128 v[152:155], v200 offset:48
ds_read_b128 v[156:159], v201 offset:48
ds_read_b128 v[160:163], v200 offset:64
ds_read_b128 v[164:167], v201 offset:64
buffer_load_dword v27, v12, s[60:63], s57 offen
buffer_load_dword v26, v9, s[64:67], s58 offen
s_waitcnt lgkmcnt(8)
v_mfma_f32_32x32x16_bf16 v[32:47], v[128:131], v[96:99], 0
v_mfma_f32_32x32x16_bf16 v[48:63], v[132:135], v[96:99], 0
s_waitcnt lgkmcnt(6)
v_mfma_f32_32x32x16_bf16 v[32:47], v[136:139], v[100:103], v[32:47]
v_mfma_f32_32x32x16_bf16 v[48:63], v[140:143], v[100:103], v[48:63]
s_waitcnt lgkmcnt(4)
v_mfma_f32_32x32x16_bf16 v[32:47], v[144:147], v[104:107], v[32:47]
v_mfma_f32_32x32x16_bf16 v[48:63], v[148:151], v[104:107], v[48:63]
s_waitcnt lgkmcnt(2)
v_mfma_f32_32x32x16_bf16 v[32:47], v[152:155], v[108:111], v[32:47]
v_mfma_f32_32x32x16_bf16 v[48:63], v[156:159], v[108:111], v[48:63]
s_waitcnt lgkmcnt(0)
v_mfma_f32_32x32x16_bf16 v[32:47], v[160:163], v[112:115], v[32:47]
v_mfma_f32_32x32x16_bf16 v[48:63], v[164:167], v[112:115], v[48:63]
ds_read_b64_tr_b16 a[0:1], v208 offset:0
ds_read_b64_tr_b16 a[2:3], v208 offset:512
ds_read_b64_tr_b16 a[4:5], v209 offset:0
ds_read_b64_tr_b16 a[6:7], v209 offset:512
ds_read_b64_tr_b16 a[8:9], v210 offset:0
ds_read_b64_tr_b16 a[10:11], v210 offset:512
ds_read_b64_tr_b16 a[12:13], v211 offset:0
ds_read_b64_tr_b16 a[14:15], v211 offset:512
s_waitcnt lgkmcnt(8)
s_nop 2
v_add_f32 v192, 0x358637bd, v52
v_rcp_f32 v192, v192
s_nop 0
v_pk_mul_f32 v[32:33], v[32:33], v[192:193] op_sel_hi:[1,0]
v_pk_mul_f32 v[34:35], v[34:35], v[192:193] op_sel_hi:[1,0]
v_pk_mul_f32 v[36:37], v[36:37], v[192:193] op_sel_hi:[1,0]
v_pk_mul_f32 v[38:39], v[38:39], v[192:193] op_sel_hi:[1,0]
v_pk_mul_f32 v[40:41], v[40:41], v[192:193] op_sel_hi:[1,0]
v_pk_mul_f32 v[42:43], v[42:43], v[192:193] op_sel_hi:[1,0]
v_pk_mul_f32 v[44:45], v[44:45], v[192:193] op_sel_hi:[1,0]
v_pk_mul_f32 v[46:47], v[46:47], v[192:193] op_sel_hi:[1,0]
v_pk_mul_f32 v[48:49], v[48:49], v[192:193] op_sel_hi:[1,0]
v_pk_mul_f32 v[50:51], v[50:51], v[192:193] op_sel_hi:[1,0]
v_cvt_pk_bf16_f32 v128, v32, v33
v_cvt_pk_bf16_f32 v129, v34, v35
v_cvt_pk_bf16_f32 v130, v36, v37
v_cvt_pk_bf16_f32 v131, v38, v39
v_cvt_pk_bf16_f32 v132, v40, v41
v_cvt_pk_bf16_f32 v133, v42, v43
v_cvt_pk_bf16_f32 v134, v44, v45
v_cvt_pk_bf16_f32 v135, v46, v47
v_cvt_pk_bf16_f32 v136, v48, v49
v_cvt_pk_bf16_f32 v137, v50, v51
buffer_store_dwordx4 v[128:131], v206, s[8:11], s33 offen sc1
buffer_store_dwordx4 v[132:135], v206, s[8:11], s33 offen offset:256 sc1
buffer_store_dwordx2 v[136:137], v207, s[8:11], s33 offen offset:1024 sc1
ds_read_b64_tr_b16 a[16:17], v208 offset:4096
ds_read_b64_tr_b16 a[18:19], v208 offset:4608
ds_read_b64_tr_b16 a[20:21], v209 offset:4096
ds_read_b64_tr_b16 a[22:23], v209 offset:4608
ds_read_b64_tr_b16 a[24:25], v210 offset:4096
ds_read_b64_tr_b16 a[26:27], v210 offset:4608
ds_read_b64_tr_b16 a[28:29], v211 offset:4096
ds_read_b64_tr_b16 a[30:31], v211 offset:4608
s_waitcnt lgkmcnt(8)
ds_read_b64_tr_b16 a[32:33], v208 offset:8192
ds_read_b64_tr_b16 a[34:35], v208 offset:8704
ds_read_b64_tr_b16 a[36:37], v209 offset:8192
ds_read_b64_tr_b16 a[38:39], v209 offset:8704
ds_read_b64_tr_b16 a[40:41], v210 offset:8192
ds_read_b64_tr_b16 a[42:43], v210 offset:8704
ds_read_b64_tr_b16 a[44:45], v211 offset:8192
ds_read_b64_tr_b16 a[46:47], v211 offset:8704
s_waitcnt lgkmcnt(8)
ds_read_b64_tr_b16 a[48:49], v208 offset:12288
ds_read_b64_tr_b16 a[50:51], v208 offset:12800
ds_read_b64_tr_b16 a[52:53], v209 offset:12288
ds_read_b64_tr_b16 a[54:55], v209 offset:12800
ds_read_b64_tr_b16 a[56:57], v210 offset:12288
ds_read_b64_tr_b16 a[58:59], v210 offset:12800
ds_read_b64_tr_b16 a[60:61], v211 offset:12288
ds_read_b64_tr_b16 a[62:63], v211 offset:12800
s_waitcnt lgkmcnt(8)
ds_read_b64_tr_b16 a[64:65], v208 offset:16384
ds_read_b64_tr_b16 a[66:67], v208 offset:16896
ds_read_b64_tr_b16 a[68:69], v209 offset:16384
ds_read_b64_tr_b16 a[70:71], v209 offset:16896
ds_read_b64_tr_b16 a[72:73], v210 offset:16384
ds_read_b64_tr_b16 a[74:75], v210 offset:16896
ds_read_b64_tr_b16 a[76:77], v211 offset:16384
ds_read_b64_tr_b16 a[78:79], v211 offset:16896
s_waitcnt lgkmcnt(8)
s_waitcnt lgkmcnt(0)
s_add_u32 m0, s50, 0
s_add_u32 s53, s48, 491520
buffer_load_dwordx4 v230, s[60:63], s53 offen offset:0 lds
buffer_load_dwordx4 v231, s[60:63], s53 offen offset:1024 lds
buffer_load_dwordx4 v232, s[60:63], s53 offen offset:2048 lds
buffer_load_dwordx4 v233, s[60:63], s53 offen offset:3072 lds
s_add_u32 m0, s50, 4096
s_add_u32 s53, s48, 589824
buffer_load_dwordx4 v230, s[60:63], s53 offen offset:0 lds
buffer_load_dwordx4 v231, s[60:63], s53 offen offset:1024 lds
buffer_load_dwordx4 v232, s[60:63], s53 offen offset:2048 lds
buffer_load_dwordx4 v233, s[60:63], s53 offen offset:3072 lds
s_waitcnt vmcnt(8)
s_barrier
s_cmp_lg_u32 s20, 0
s_cbranch_scc1 mn_nf10
s_mov_b64 exec, 1
v_mov_b32 v30, s69
buffer_store_dword v30, v255, s[8:11], s6 offen sc1
s_mov_b64 exec, -1
mn_nf10:
s_add_u32 m0, s50, 8192
s_add_u32 s53, s48, 688128
buffer_load_dwordx4 v230, s[60:63], s53 offen offset:0 lds
buffer_load_dwordx4 v231, s[60:63], s53 offen offset:1024 lds
buffer_load_dwordx4 v232, s[60:63], s53 offen offset:2048 lds
buffer_load_dwordx4 v233, s[60:63], s53 offen offset:3072 lds
s_add_u32 m0, s50, 12288
s_add_u32 s53, s48, 786432
buffer_load_dwordx4 v230, s[60:63], s53 offen offset:0 lds
buffer_load_dwordx4 v231, s[60:63], s53 offen offset:1024 lds
buffer_load_dwordx4 v232, s[60:63], s53 offen offset:2048 lds
buffer_load_dwordx4 v233, s[60:63], s53 offen offset:3072 lds
s_add_u32 m0, s50, 16384
s_add_u32 s53, s48, 884736
buffer_load_dwordx4 v230, s[60:63], s53 offen offset:0 lds
buffer_load_dwordx4 v231, s[60:63], s53 offen offset:1024 lds
buffer_load_dwordx4 v232, s[60:63], s53 offen offset:2048 lds
buffer_load_dwordx4 v233, s[60:63], s53 offen offset:3072 lds
s_lshr_b32 s3, s23, 1
s_lshl_b32 s3, s3, 2
s_add_u32 s3, s3, s20
s_lshl_b32 s3, s3, 9
s_add_u32 s3, s3, s27
s_add_u32 s6, s3, 12468224
v_lshlrev_b32 v28, 7, v1
s_mul_i32 s7, s20, 5120
s_lshl_b32 s34, s23, 2
s_add_u32 s3, s20, 0
s_and_b32 s3, s3, 3
s_add_u32 s3, s3, s34
s_mul_i32 s3, s3, 20480
s_add_u32 s3, s3, s7
s_add_u32 s3, s3, s27
s_add_u32 s30, s3, 2621440
s_add_u32 s3, s20, 1
s_and_b32 s3, s3, 3
s_add_u32 s3, s3, s34
s_mul_i32 s3, s3, 20480
s_add_u32 s3, s3, s7
s_add_u32 s3, s3, s27
s_add_u32 s31, s3, 2621440
s_add_u32 s3, s20, 2
s_and_b32 s3, s3, 3
s_add_u32 s3, s3, s34
s_mul_i32 s3, s3, 20480
s_add_u32 s3, s3, s7
s_add_u32 s3, s3, s27
s_add_u32 s32, s3, 2621440
s_add_u32 s3, s20, 3
s_and_b32 s3, s3, 3
s_add_u32 s3, s3, s34
s_mul_i32 s3, s3, 20480
s_add_u32 s3, s3, s7
s_add_u32 s3, s3, s27
s_add_u32 s33, s3, 2621440
v_mfma_f32_16x16x32_bf16 v[112:115], v[244:247], v[236:239], 0
v_mfma_f32_16x16x32_bf16 v[116:119], v[246:249], v[236:239], 0
v_mfma_f32_16x16x32_bf16 v[120:123], v[248:251], v[236:239], 0
v_mfma_f32_16x16x32_bf16 v[124:127], v[250:253], v[236:239], 0
v_mfma_f32_16x16x32_bf16 v[128:131], v[252:255], v[236:239], 0
s_add_u32 s3, s20, 1
s_and_b32 s3, s3, 3
s_lshr_b32 s4, s3, 1
s_mul_i32 s4, s4, 92160
s_mul_i32 s3, s3, 15360
s_add_u32 s3, s3, 0
s_add_u32 s3, s3, s4
v_add_u32 v8, s3, v2
s_add_u32 s3, s20, 2
s_and_b32 s3, s3, 3
s_lshr_b32 s4, s3, 1
s_mul_i32 s4, s4, 92160
s_mul_i32 s3, s3, 15360
s_add_u32 s3, s3, 5120
s_add_u32 s3, s3, s4
v_add_u32 v9, s3, v2
s_add_u32 s3, s20, 3
s_and_b32 s3, s3, 3
s_lshr_b32 s4, s3, 1
s_mul_i32 s4, s4, 92160
s_mul_i32 s3, s3, 15360
s_add_u32 s3, s3, 10240
s_add_u32 s3, s3, s4
v_add_u32 v10, s3, v2
s_add_u32 s3, s20, 0
s_and_b32 s3, s3, 3
s_lshr_b32 s4, s3, 1
s_mul_i32 s4, s4, 92160
s_mul_i32 s3, s3, 15360
s_add_u32 s3, s3, 0
s_add_u32 s3, s3, s4
v_add_u32 v11, s3, v2
s_lshr_b32 s3, s20, 1
s_lshl_b32 s35, s23, 1
s_add_u32 s35, s35, s3
s_and_b32 s36, s20, 1
s_mul_i32 s3, s24, 327680
s_lshl_b32 s4, s35, 10
s_add_u32 s3, s3, s4
s_lshl_b32 s4, s36, 9
s_add_u32 s3, s3, s4
s_add_u32 s3, s3, s27
s_add_u32 s37, s3, 5242880
s_add_u32 s3, s34, s20
s_lshl_b32 s3, s3, 10
s_add_u32 s3, s3, s27
s_add_u32 s38, s3, 12320768
s_lshl_b32 s3, s24, 7
s_add_u32 s39, s38, s3
v_lshrrev_b32 v12, 2, v1
v_lshlrev_b32 v12, 3, v12
v_and_b32 v13, 7, v1
v_lshlrev_b32 v13, 7, v13
v_lshl_add_u32 v13, v5, 5, v13
v_bfe_u32 v14, v1, 3, 1
v_lshl_add_u32 v13, v14, 4, v13
v_and_b32 v14, 1, v5
v_lshlrev_b32 v14, 16, v14
v_lshl_add_u32 v14, v4, 4, v14
v_lshrrev_b32 v15, 1, v5
v_lshl_add_u32 v14, v15, 8, v14
s_mov_b64 exec, 15
s_mov_b32 s5, 262144
mn_poll11:
buffer_load_dword v29, v28, s[8:11], s6 offen sc1
s_sub_u32 s5, s5, 1
s_cbranch_scc1 mn_pout12
s_waitcnt vmcnt(0)
v_cmpx_ne_u32 vcc, s69, v29
s_cbranch_execnz mn_poll11
mn_pout12:
s_waitcnt vmcnt(0)
s_mov_b64 exec, -1
s_nop 3
buffer_load_dwordx4 v[32:35], v2, s[8:11], s30 offen offset:0 sc1
ds_read_b64_tr_b16 a[80:81], v208 offset:0
ds_read_b64_tr_b16 a[82:83], v208 offset:512
buffer_load_dwordx4 v[36:39], v2, s[8:11], s31 offen offset:0 sc1
ds_read_b64_tr_b16 a[84:85], v209 offset:0
ds_read_b64_tr_b16 a[86:87], v209 offset:512
buffer_load_dwordx4 v[40:43], v2, s[8:11], s32 offen offset:0 sc1
ds_read_b64_tr_b16 a[88:89], v210 offset:0
ds_read_b64_tr_b16 a[90:91], v210 offset:512
buffer_load_dwordx4 v[44:47], v2, s[8:11], s33 offen offset:0 sc1
ds_read_b64_tr_b16 a[92:93], v211 offset:0
ds_read_b64_tr_b16 a[94:95], v211 offset:512
s_waitcnt lgkmcnt(8)
buffer_load_dwordx4 v[48:51], v2, s[8:11], s30 offen offset:1024 sc1
ds_read_b64_tr_b16 a[96:97], v208 offset:4096
ds_read_b64_tr_b16 a[98:99], v208 offset:4608
buffer_load_dwordx4 v[52:55], v2, s[8:11], s31 offen offset:1024 sc1
ds_read_b64_tr_b16 a[100:101], v209 offset:4096
ds_read_b64_tr_b16 a[102:103], v209 offset:4608
buffer_load_dwordx4 v[56:59], v2, s[8:11], s32 offen offset:1024 sc1
ds_read_b64_tr_b16 a[104:105], v210 offset:4096
ds_read_b64_tr_b16 a[106:107], v210 offset:4608
buffer_load_dwordx4 v[60:63], v2, s[8:11], s33 offen offset:1024 sc1
ds_read_b64_tr_b16 a[108:109], v211 offset:4096
ds_read_b64_tr_b16 a[110:111], v211 offset:4608
s_waitcnt lgkmcnt(8)
buffer_load_dwordx4 v[64:67], v2, s[8:11], s30 offen offset:2048 sc1
ds_read_b64_tr_b16 a[112:113], v208 offset:8192
ds_read_b64_tr_b16 a[114:115], v208 offset:8704
buffer_load_dwordx4 v[68:71], v2, s[8:11], s31 offen offset:2048 sc1
ds_read_b64_tr_b16 a[116:117], v209 offset:8192
ds_read_b64_tr_b16 a[118:119], v209 offset:8704
buffer_load_dwordx4 v[72:75], v2, s[8:11], s32 offen offset:2048 sc1
ds_read_b64_tr_b16 a[120:121], v210 offset:8192
ds_read_b64_tr_b16 a[122:123], v210 offset:8704
buffer_load_dwordx4 v[76:79], v2, s[8:11], s33 offen offset:2048 sc1
ds_read_b64_tr_b16 a[124:125], v211 offset:8192
ds_read_b64_tr_b16 a[126:127], v211 offset:8704
s_waitcnt lgkmcnt(8)
buffer_load_dwordx4 v[80:83], v2, s[8:11], s30 offen offset:3072 sc1
ds_read_b64_tr_b16 a[128:129], v208 offset:12288
ds_read_b64_tr_b16 a[130:131], v208 offset:12800
buffer_load_dwordx4 v[84:87], v2, s[8:11], s31 offen offset:3072 sc1
ds_read_b64_tr_b16 a[132:133], v209 offset:12288
ds_read_b64_tr_b16 a[134:135], v209 offset:12800
buffer_load_dwordx4 v[88:91], v2, s[8:11], s32 offen offset:3072 sc1
ds_read_b64_tr_b16 a[136:137], v210 offset:12288
ds_read_b64_tr_b16 a[138:139], v210 offset:12800
buffer_load_dwordx4 v[92:95], v2, s[8:11], s33 offen offset:3072 sc1
ds_read_b64_tr_b16 a[140:141], v211 offset:12288
ds_read_b64_tr_b16 a[142:143], v211 offset:12800
s_waitcnt lgkmcnt(8)
buffer_load_dwordx4 v[96:99], v3, s[8:11], s30 offen offset:0 sc1
ds_read_b64_tr_b16 a[144:145], v208 offset:16384
ds_read_b64_tr_b16 a[146:147], v208 offset:16896
buffer_load_dwordx4 v[100:103], v3, s[8:11], s31 offen offset:0 sc1
ds_read_b64_tr_b16 a[148:149], v209 offset:16384
ds_read_b64_tr_b16 a[150:151], v209 offset:16896
buffer_load_dwordx4 v[104:107], v3, s[8:11], s32 offen offset:0 sc1
ds_read_b64_tr_b16 a[152:153], v210 offset:16384
ds_read_b64_tr_b16 a[154:155], v210 offset:16896
buffer_load_dwordx4 v[108:111], v3, s[8:11], s33 offen offset:0 sc1
ds_read_b64_tr_b16 a[156:157], v211 offset:16384
ds_read_b64_tr_b16 a[158:159], v211 offset:16896
s_waitcnt lgkmcnt(8)
s_lshl_b32 s3, s23, 3
s_add_u32 s3, s3, s24
s_lshl_b32 s3, s3, 7
s_add_u32 s3, s3, s27
s_add_u32 s6, s3, 12500992
s_waitcnt lgkmcnt(0)
s_waitcnt vmcnt(16)
v_mfma_f32_16x16x32_bf16 v[112:115], v[32:35], a[160:163], v[112:115]
s_add_u32 m0, s50, 0
s_add_u32 s53, s48, 983040
buffer_load_dwordx4 v230, s[60:63], s53 offen offset:0 lds
v_mfma_f32_16x16x32_bf16 v[116:119], v[32:35], a[164:167], v[116:119]
v_mfma_f32_16x16x32_bf16 v[120:123], v[32:35], a[168:171], v[120:123]
v_mfma_f32_16x16x32_bf16 v[124:127], v[32:35], a[172:175], v[124:127]
v_mfma_f32_16x16x32_bf16 v[128:131], v[32:35], a[176:179], v[128:131]
v_mfma_f32_16x16x32_bf16 v[132:135], v[36:39], a[160:163], 0
v_mfma_f32_16x16x32_bf16 v[136:139], v[36:39], a[164:167], 0
buffer_load_dwordx4 v231, s[60:63], s53 offen offset:1024 lds
v_mfma_f32_16x16x32_bf16 v[140:143], v[36:39], a[168:171], 0
v_mfma_f32_16x16x32_bf16 v[144:147], v[36:39], a[172:175], 0
v_mfma_f32_16x16x32_bf16 v[148:151], v[36:39], a[176:179], 0
v_mfma_f32_16x16x32_bf16 v[152:155], v[40:43], a[160:163], 0
v_mfma_f32_16x16x32_bf16 v[156:159], v[40:43], a[164:167], 0
v_mfma_f32_16x16x32_bf16 v[160:163], v[40:43], a[168:171], 0
v_mfma_f32_16x16x32_bf16 v[164:167], v[40:43], a[172:175], 0
buffer_load_dwordx4 v232, s[60:63], s53 offen offset:2048 lds
v_mfma_f32_16x16x32_bf16 v[168:171], v[40:43], a[176:179], 0
v_mfma_f32_16x16x32_bf16 v[172:175], v[44:47], a[160:163], 0
v_mfma_f32_16x16x32_bf16 v[176:179], v[44:47], a[164:167], 0
v_mfma_f32_16x16x32_bf16 v[180:183], v[44:47], a[168:171], 0
v_mfma_f32_16x16x32_bf16 v[184:187], v[44:47], a[172:175], 0
v_mfma_f32_16x16x32_bf16 v[188:191], v[44:47], a[176:179], 0
s_waitcnt vmcnt(15)
v_mfma_f32_16x16x32_bf16 v[112:115], v[48:51], a[180:183], v[112:115]
buffer_load_dwordx4 v233, s[60:63], s53 offen offset:3072 lds
v_mfma_f32_16x16x32_bf16 v[116:119], v[48:51], a[184:187], v[116:119]
v_mfma_f32_16x16x32_bf16 v[120:123], v[48:51], a[188:191], v[120:123]
v_mfma_f32_16x16x32_bf16 v[124:127], v[48:51], a[192:195], v[124:127]
v_mfma_f32_16x16x32_bf16 v[128:131], v[48:51], a[196:199], v[128:131]
v_mfma_f32_16x16x32_bf16 v[132:135], v[52:55], a[180:183], v[132:135]
v_mfma_f32_16x16x32_bf16 v[136:139], v[52:55], a[184:187], v[136:139]
s_add_u32 m0, s50, 4096
s_add_u32 s53, s48, 1081344
buffer_load_dwordx4 v230, s[60:63], s53 offen offset:0 lds
v_mfma_f32_16x16x32_bf16 v[140:143], v[52:55], a[188:191], v[140:143]
v_mfma_f32_16x16x32_bf16 v[144:147], v[52:55], a[192:195], v[144:147]
v_mfma_f32_16x16x32_bf16 v[148:151], v[52:55], a[196:199], v[148:151]
v_mfma_f32_16x16x32_bf16 v[152:155], v[56:59], a[180:183], v[152:155]
v_mfma_f32_16x16x32_bf16 v[156:159], v[56:59], a[184:187], v[156:159]
v_mfma_f32_16x16x32_bf16 v[160:163], v[56:59], a[188:191], v[160:163]
v_mfma_f32_16x16x32_bf16 v[164:167], v[56:59], a[192:195], v[164:167]
buffer_load_dwordx4 v231, s[60:63], s53 offen offset:1024 lds
v_mfma_f32_16x16x32_bf16 v[168:171], v[56:59], a[196:199], v[168:171]
v_mfma_f32_16x16x32_bf16 v[172:175], v[60:63], a[180:183], v[172:175]
v_mfma_f32_16x16x32_bf16 v[176:179], v[60:63], a[184:187], v[176:179]
v_mfma_f32_16x16x32_bf16 v[180:183], v[60:63], a[188:191], v[180:183]
v_mfma_f32_16x16x32_bf16 v[184:187], v[60:63], a[192:195], v[184:187]
v_mfma_f32_16x16x32_bf16 v[188:191], v[60:63], a[196:199], v[188:191]
s_waitcnt vmcnt(14)
v_mfma_f32_16x16x32_bf16 v[112:115], v[64:67], a[200:203], v[112:115]
buffer_load_dwordx4 v232, s[60:63], s53 offen offset:2048 lds
v_mfma_f32_16x16x32_bf16 v[116:119], v[64:67], a[204:207], v[116:119]
v_mfma_f32_16x16x32_bf16 v[120:123], v[64:67], a[208:211], v[120:123]
v_mfma_f32_16x16x32_bf16 v[124:127], v[64:67], a[212:215], v[124:127]
v_mfma_f32_16x16x32_bf16 v[128:131], v[64:67], a[216:219], v[128:131]
v_mfma_f32_16x16x32_bf16 v[132:135], v[68:71], a[200:203], v[132:135]
v_mfma_f32_16x16x32_bf16 v[136:139], v[68:71], a[204:207], v[136:139]
buffer_load_dwordx4 v233, s[60:63], s53 offen offset:3072 lds
v_mfma_f32_16x16x32_bf16 v[140:143], v[68:71], a[208:211], v[140:143]
v_mfma_f32_16x16x32_bf16 v[144:147], v[68:71], a[212:215], v[144:147]
v_mfma_f32_16x16x32_bf16 v[148:151], v[68:71], a[216:219], v[148:151]
v_mfma_f32_16x16x32_bf16 v[152:155], v[72:75], a[200:203], v[152:155]
v_mfma_f32_16x16x32_bf16 v[156:159], v[72:75], a[204:207], v[156:159]
v_mfma_f32_16x16x32_bf16 v[160:163], v[72:75], a[208:211], v[160:163]
v_mfma_f32_16x16x32_bf16 v[164:167], v[72:75], a[212:215], v[164:167]
s_add_u32 m0, s50, 8192
s_add_u32 s53, s48, 1179648
buffer_load_dwordx4 v230, s[60:63], s53 offen offset:0 lds
v_mfma_f32_16x16x32_bf16 v[168:171], v[72:75], a[216:219], v[168:171]
v_mfma_f32_16x16x32_bf16 v[172:175], v[76:79], a[200:203], v[172:175]
v_mfma_f32_16x16x32_bf16 v[176:179], v[76:79], a[204:207], v[176:179]
v_mfma_f32_16x16x32_bf16 v[180:183], v[76:79], a[208:211], v[180:183]
v_mfma_f32_16x16x32_bf16 v[184:187], v[76:79], a[212:215], v[184:187]
v_mfma_f32_16x16x32_bf16 v[188:191], v[76:79], a[216:219], v[188:191]
s_waitcnt vmcnt(13)
v_mfma_f32_16x16x32_bf16 v[112:115], v[80:83], a[220:223], v[112:115]
buffer_load_dwordx4 v231, s[60:63], s53 offen offset:1024 lds
v_mfma_f32_16x16x32_bf16 v[116:119], v[80:83], a[224:227], v[116:119]
v_mfma_f32_16x16x32_bf16 v[120:123], v[80:83], a[228:231], v[120:123]
v_mfma_f32_16x16x32_bf16 v[124:127], v[80:83], a[232:235], v[124:127]
v_mfma_f32_16x16x32_bf16 v[128:131], v[80:83], a[236:239], v[128:131]
v_mfma_f32_16x16x32_bf16 v[132:135], v[84:87], a[220:223], v[132:135]
v_mfma_f32_16x16x32_bf16 v[136:139], v[84:87], a[224:227], v[136:139]
buffer_load_dwordx4 v232, s[60:63], s53 offen offset:2048 lds
v_mfma_f32_16x16x32_bf16 v[140:143], v[84:87], a[228:231], v[140:143]
v_mfma_f32_16x16x32_bf16 v[144:147], v[84:87], a[232:235], v[144:147]
v_mfma_f32_16x16x32_bf16 v[148:151], v[84:87], a[236:239], v[148:151]
v_mfma_f32_16x16x32_bf16 v[152:155], v[88:91], a[220:223], v[152:155]
v_mfma_f32_16x16x32_bf16 v[156:159], v[88:91], a[224:227], v[156:159]
v_mfma_f32_16x16x32_bf16 v[160:163], v[88:91], a[228:231], v[160:163]
v_mfma_f32_16x16x32_bf16 v[164:167], v[88:91], a[232:235], v[164:167]
buffer_load_dwordx4 v233, s[60:63], s53 offen offset:3072 lds
v_mfma_f32_16x16x32_bf16 v[168:171], v[88:91], a[236:239], v[168:171]
v_mfma_f32_16x16x32_bf16 v[172:175], v[92:95], a[220:223], v[172:175]
v_mfma_f32_16x16x32_bf16 v[176:179], v[92:95], a[224:227], v[176:179]
v_mfma_f32_16x16x32_bf16 v[180:183], v[92:95], a[228:231], v[180:183]
v_mfma_f32_16x16x32_bf16 v[184:187], v[92:95], a[232:235], v[184:187]
v_mfma_f32_16x16x32_bf16 v[188:191], v[92:95], a[236:239], v[188:191]
s_waitcnt vmcnt(12)
v_mfma_f32_16x16x32_bf16 v[112:115], v[96:99], a[240:243], v[112:115]
s_add_u32 m0, s50, 12288
s_add_u32 s53, s48, 1277952
buffer_load_dwordx4 v230, s[60:63], s53 offen offset:0 lds
v_mfma_f32_16x16x32_bf16 v[116:119], v[96:99], a[244:247], v[116:119]
v_mfma_f32_16x16x32_bf16 v[120:123], v[96:99], a[248:251], v[120:123]
v_mfma_f32_16x16x32_bf16 v[124:127], v[96:99], a[252:255], v[124:127]
v_mfma_f32_16x16x32_bf16 v[128:131], v[96:99], v[240:243], v[128:131]
v_mfma_f32_16x16x32_bf16 v[132:135], v[100:103], a[240:243], v[132:135]
v_mfma_f32_16x16x32_bf16 v[136:139], v[100:103], a[244:247], v[136:139]
buffer_load_dwordx4 v231, s[60:63], s53 offen offset:1024 lds
v_mfma_f32_16x16x32_bf16 v[140:143], v[100:103], a[248:251], v[140:143]
v_mfma_f32_16x16x32_bf16 v[144:147], v[100:103], a[252:255], v[144:147]
v_mfma_f32_16x16x32_bf16 v[148:151], v[100:103], v[240:243], v[148:151]
v_mfma_f32_16x16x32_bf16 v[152:155], v[104:107], a[240:243], v[152:155]
v_mfma_f32_16x16x32_bf16 v[156:159], v[104:107], a[244:247], v[156:159]
v_mfma_f32_16x16x32_bf16 v[160:163], v[104:107], a[248:251], v[160:163]
v_mfma_f32_16x16x32_bf16 v[164:167], v[104:107], a[252:255], v[164:167]
buffer_load_dwordx4 v232, s[60:63], s53 offen offset:2048 lds
v_mfma_f32_16x16x32_bf16 v[168:171], v[104:107], v[240:243], v[168:171]
v_mfma_f32_16x16x32_bf16 v[172:175], v[108:111], a[240:243], v[172:175]
v_mfma_f32_16x16x32_bf16 v[176:179], v[108:111], a[244:247], v[176:179]
v_mfma_f32_16x16x32_bf16 v[180:183], v[108:111], a[248:251], v[180:183]
v_mfma_f32_16x16x32_bf16 v[184:187], v[108:111], a[252:255], v[184:187]
v_mfma_f32_16x16x32_bf16 v[188:191], v[108:111], v[240:243], v[188:191]
ds_write_b128 v8, v[132:135] offset:0
buffer_load_dwordx4 v233, s[60:63], s53 offen offset:3072 lds
ds_write_b128 v8, v[136:139] offset:1024
ds_write_b128 v8, v[140:143] offset:2048
ds_write_b128 v8, v[144:147] offset:3072
ds_write_b128 v8, v[148:151] offset:4096
ds_write_b128 v9, v[152:155] offset:0
s_add_u32 m0, s50, 16384
s_add_u32 s53, s48, 1376256
buffer_load_dwordx4 v230, s[60:63], s53 offen offset:0 lds
ds_write_b128 v9, v[156:159] offset:1024
ds_write_b128 v9, v[160:163] offset:2048
ds_write_b128 v9, v[164:167] offset:3072
ds_write_b128 v9, v[168:171] offset:4096
ds_write_b128 v10, v[172:175] offset:0
buffer_load_dwordx4 v231, s[60:63], s53 offen offset:1024 lds
ds_write_b128 v10, v[176:179] offset:1024
ds_write_b128 v10, v[180:183] offset:2048
ds_write_b128 v10, v[184:187] offset:3072
ds_write_b128 v10, v[188:191] offset:4096
s_waitcnt lgkmcnt(0)
s_barrier
ds_read_b128 v[32:35], v11 offset:0
buffer_load_dwordx4 v232, s[60:63], s53 offen offset:2048 lds
ds_read_b128 v[36:39], v11 offset:1024
ds_read_b128 v[40:43], v11 offset:2048
ds_read_b128 v[44:47], v11 offset:3072
ds_read_b128 v[48:51], v11 offset:4096
ds_read_b128 v[52:55], v11 offset:5120
ds_read_b128 v[56:59], v11 offset:6144
ds_read_b128 v[60:63], v11 offset:7168
buffer_load_dwordx4 v233, s[60:63], s53 offen offset:3072 lds
ds_read_b128 v[64:67], v11 offset:8192
ds_read_b128 v[68:71], v11 offset:9216
ds_read_b128 v[72:75], v11 offset:10240
ds_read_b128 v[76:79], v11 offset:11264
ds_read_b128 v[80:83], v11 offset:12288
ds_read_b128 v[84:87], v11 offset:13312
ds_read_b128 v[88:91], v11 offset:14336
s_waitcnt lgkmcnt(10)
v_pk_add_f32 v[92:93], v[112:113], v[32:33]
v_pk_add_f32 v[94:95], v[114:115], v[34:35]
v_pk_add_f32 v[96:97], v[116:117], v[36:37]
v_pk_add_f32 v[98:99], v[118:119], v[38:39]
v_pk_add_f32 v[100:101], v[120:121], v[40:41]
v_pk_add_f32 v[102:103], v[122:123], v[42:43]
v_pk_add_f32 v[104:105], v[124:125], v[44:45]
v_pk_add_f32 v[106:107], v[126:127], v[46:47]
v_pk_add_f32 v[108:109], v[128:129], v[48:49]
v_pk_add_f32 v[110:111], v[130:131], v[50:51]
s_mov_b32 m0, s51
s_add_u32 s53, s48, 1474560
buffer_load_dwordx4 v230, s[60:63], s53 offen offset:0 lds
s_waitcnt lgkmcnt(5)
v_pk_add_f32 v[92:93], v[92:93], v[52:53]
v_pk_add_f32 v[94:95], v[94:95], v[54:55]
v_pk_add_f32 v[96:97], v[96:97], v[56:57]
v_pk_add_f32 v[98:99], v[98:99], v[58:59]
v_pk_add_f32 v[100:101], v[100:101], v[60:61]
v_pk_add_f32 v[102:103], v[102:103], v[62:63]
v_pk_add_f32 v[104:105], v[104:105], v[64:65]
v_pk_add_f32 v[106:107], v[106:107], v[66:67]
v_pk_add_f32 v[108:109], v[108:109], v[68:69]
v_pk_add_f32 v[110:111], v[110:111], v[70:71]
buffer_load_dwordx4 v231, s[60:63], s53 offen offset:1024 lds
s_waitcnt lgkmcnt(0)
v_pk_add_f32 v[92:93], v[92:93], v[72:73]
v_pk_add_f32 v[94:95], v[94:95], v[74:75]
v_pk_add_f32 v[96:97], v[96:97], v[76:77]
v_pk_add_f32 v[98:99], v[98:99], v[78:79]
v_pk_add_f32 v[100:101], v[100:101], v[80:81]
v_pk_add_f32 v[102:103], v[102:103], v[82:83]
v_pk_add_f32 v[104:105], v[104:105], v[84:85]
v_pk_add_f32 v[106:107], v[106:107], v[86:87]
v_pk_add_f32 v[108:109], v[108:109], v[88:89]
v_pk_add_f32 v[110:111], v[110:111], v[90:91]
buffer_load_dwordx4 v232, s[60:63], s53 offen offset:2048 lds
v_pk_add_f32 v[32:33], v[92:93], v[96:97]
buffer_load_dwordx4 v233, s[60:63], s53 offen offset:3072 lds
v_pk_add_f32 v[34:35], v[94:95], v[98:99]
v_pk_mul_f32 v[36:37], v[92:93], v[92:93]
v_pk_mul_f32 v[38:39], v[94:95], v[94:95]
v_pk_fma_f32 v[36:37], v[96:97], v[96:97], v[36:37]
v_pk_fma_f32 v[38:39], v[98:99], v[98:99], v[38:39]
v_pk_add_f32 v[32:33], v[32:33], v[100:101]
v_pk_fma_f32 v[36:37], v[100:101], v[100:101], v[36:37]
v_pk_add_f32 v[34:35], v[34:35], v[102:103]
v_pk_fma_f32 v[38:39], v[102:103], v[102:103], v[38:39]
v_pk_add_f32 v[32:33], v[32:33], v[104:105]
v_pk_fma_f32 v[36:37], v[104:105], v[104:105], v[36:37]
v_pk_add_f32 v[34:35], v[34:35], v[106:107]
v_pk_fma_f32 v[38:39], v[106:107], v[106:107], v[38:39]
v_pk_add_f32 v[32:33], v[32:33], v[108:109]
v_pk_fma_f32 v[36:37], v[108:109], v[108:109], v[36:37]
v_pk_add_f32 v[34:35], v[34:35], v[110:111]
v_pk_fma_f32 v[38:39], v[110:111], v[110:111], v[38:39]
v_add_f32_dpp v40, v32, v32 row_ror:8 row_mask:0xf bank_mask:0x3
s_nop 1
v_add_f32_dpp v40, v34, v34 row_ror:8 row_mask:0xf bank_mask:0xc
v_add_f32_dpp v41, v33, v33 row_ror:8 row_mask:0xf bank_mask:0x3
s_nop 1
v_add_f32_dpp v41, v35, v35 row_ror:8 row_mask:0xf bank_mask:0xc
v_add_f32_dpp v42, v36, v36 row_ror:8 row_mask:0xf bank_mask:0x3
s_nop 1
v_add_f32_dpp v42, v38, v38 row_ror:8 row_mask:0xf bank_mask:0xc
v_add_f32_dpp v43, v37, v37 row_ror:8 row_mask:0xf bank_mask:0x3
s_nop 1
v_add_f32_dpp v43, v39, v39 row_ror:8 row_mask:0xf bank_mask:0xc
v_add_f32_dpp v44, v40, v40 row_ror:12 row_mask:0xf bank_mask:0x5
v_add_f32_dpp v45, v42, v42 row_ror:12 row_mask:0xf bank_mask:0x5
s_nop 0
v_add_f32_dpp v44, v41, v41 row_ror:4 row_mask:0xf bank_mask:0xa
v_add_f32_dpp v45, v43, v43 row_ror:4 row_mask:0xf bank_mask:0xa
s_nop 0
v_add_f32_dpp v44, v44, v44 quad_perm:[1,0,3,2] row_mask:0xf bank_mask:0xf
v_add_f32_dpp v45, v45, v45 quad_perm:[1,0,3,2] row_mask:0xf bank_mask:0xf
s_nop 0
v_add_f32_dpp v44, v44, v44 quad_perm:[2,3,0,1] row_mask:0xf bank_mask:0xf
v_add_f32_dpp v45, v45, v45 quad_perm:[2,3,0,1] row_mask:0xf bank_mask:0xf
s_mov_b32 exec_lo, 0x11111111
s_mov_b32 exec_hi, 0x11111111
buffer_store_dwordx2 v[44:45], v12, s[8:11], s39 offen sc1
s_mov_b64 exec, -1
v_cvt_pk_bf16_f32 v244, v92, v93
v_cvt_pk_bf16_f32 v245, v94, v95
v_cvt_pk_bf16_f32 v246, v96, v97
v_cvt_pk_bf16_f32 v247, v98, v99
v_cvt_pk_bf16_f32 v248, v100, v101
v_cvt_pk_bf16_f32 v249, v102, v103
v_cvt_pk_bf16_f32 v250, v104, v105
v_cvt_pk_bf16_f32 v251, v106, v107
v_cvt_pk_bf16_f32 v252, v108, v109
v_cvt_pk_bf16_f32 v253, v110, v111
s_waitcnt vmcnt(1)
ds_read_b64_tr_b16 a[160:161], v208 offset:0
ds_read_b64_tr_b16 a[162:163], v208 offset:512
ds_read_b64_tr_b16 a[164:165], v209 offset:0
ds_read_b64_tr_b16 a[166:167], v209 offset:512
ds_read_b64_tr_b16 a[168:169], v210 offset:0
ds_read_b64_tr_b16 a[170:171], v210 offset:512
ds_read_b64_tr_b16 a[172:173], v211 offset:0
ds_read_b64_tr_b16 a[174:175], v211 offset:512
s_waitcnt lgkmcnt(8)
ds_read_b64_tr_b16 a[176:177], v208 offset:4096
ds_read_b64_tr_b16 a[178:179], v208 offset:4608
ds_read_b64_tr_b16 a[180:181], v209 offset:4096
ds_read_b64_tr_b16 a[182:183], v209 offset:4608
ds_read_b64_tr_b16 a[184:185], v210 offset:4096
ds_read_b64_tr_b16 a[186:187], v210 offset:4608
ds_read_b64_tr_b16 a[188:189], v211 offset:4096
ds_read_b64_tr_b16 a[190:191], v211 offset:4608
s_waitcnt lgkmcnt(8)
ds_read_b64_tr_b16 a[192:193], v208 offset:8192
ds_read_b64_tr_b16 a[194:195], v208 offset:8704
ds_read_b64_tr_b16 a[196:197], v209 offset:8192
ds_read_b64_tr_b16 a[198:199], v209 offset:8704
ds_read_b64_tr_b16 a[200:201], v210 offset:8192
ds_read_b64_tr_b16 a[202:203], v210 offset:8704
ds_read_b64_tr_b16 a[204:205], v211 offset:8192
ds_read_b64_tr_b16 a[206:207], v211 offset:8704
s_waitcnt lgkmcnt(8)
buffer_load_dwordx4 v[48:51], v13, s[8:11], s38 offen sc1
s_mov_b32 s5, 262144
ds_read_b64_tr_b16 a[208:209], v208 offset:12288
ds_read_b64_tr_b16 a[210:211], v208 offset:12800
ds_read_b64_tr_b16 a[212:213], v209 offset:12288
ds_read_b64_tr_b16 a[214:215], v209 offset:12800
ds_read_b64_tr_b16 a[216:217], v210 offset:12288
ds_read_b64_tr_b16 a[218:219], v210 offset:12800
ds_read_b64_tr_b16 a[220:221], v211 offset:12288
ds_read_b64_tr_b16 a[222:223], v211 offset:12800
s_waitcnt lgkmcnt(8)
ds_read_b64_tr_b16 a[224:225], v208 offset:16384
ds_read_b64_tr_b16 a[226:227], v208 offset:16896
ds_read_b64_tr_b16 a[228:229], v209 offset:16384
ds_read_b64_tr_b16 a[230:231], v209 offset:16896
ds_read_b64_tr_b16 a[232:233], v210 offset:16384
ds_read_b64_tr_b16 a[234:235], v210 offset:16896
ds_read_b64_tr_b16 a[236:237], v211 offset:16384
ds_read_b64_tr_b16 a[238:239], v211 offset:16896
s_waitcnt lgkmcnt(8)
ds_read_b64_tr_b16 a[240:241], v212 offset:0
ds_read_b64_tr_b16 a[242:243], v212 offset:512
ds_read_b64_tr_b16 a[244:245], v213 offset:0
ds_read_b64_tr_b16 a[246:247], v213 offset:512
ds_read_b64_tr_b16 a[248:249], v214 offset:0
ds_read_b64_tr_b16 a[250:251], v214 offset:512
ds_read_b64_tr_b16 a[252:253], v215 offset:0
ds_read_b64_tr_b16 a[254:255], v215 offset:512
s_waitcnt lgkmcnt(8)
mn_sxl:
s_waitcnt vmcnt(0)
v_max3_u32 v52, v48, v49, v50
v_max_u32 v52, v52, v51
v_cmp_eq_u32 vcc, -1, v52
s_cbranch_vccz mn_sxok
s_sub_u32 s5, s5, 1
s_cbranch_scc1 mn_sxok
buffer_load_dwordx4 v[48:51], v13, s[8:11], s38 offen sc1
s_branch mn_sxl
mn_sxok:
v_add_f32_dpp v54, v48, v48 row_half_mirror row_mask:0xf bank_mask:0x5
v_add_f32_dpp v55, v49, v49 row_half_mirror row_mask:0xf bank_mask:0x5
s_nop 0
v_add_f32_dpp v54, v50, v50 row_half_mirror row_mask:0xf bank_mask:0xa
v_add_f32_dpp v55, v51, v51 row_half_mirror row_mask:0xf bank_mask:0xa
s_nop 0
v_add_f32_dpp v54, v54, v54 quad_perm:[1,0,3,2] row_mask:0xf bank_mask:0xf
v_add_f32_dpp v55, v55, v55 quad_perm:[1,0,3,2] row_mask:0xf bank_mask:0xf
s_nop 0
v_add_f32_dpp v54, v54, v54 quad_perm:[2,3,0,1] row_mask:0xf bank_mask:0xf
v_add_f32_dpp v55, v55, v55 quad_perm:[2,3,0,1] row_mask:0xf bank_mask:0xf
v_mul_f32 v54, 0x3acccccd, v54
v_mul_f32 v55, 0x3acccccd, v55
v_fma_f32 v55, -v54, v54, v55
v_max_f32 v55, 0, v55
v_add_f32 v52, 0x3727c5ac, v55
v_rsq_f32 v52, v52
v_mov_b32 v53, 0x3727c5ac
v_mul_f32 v55, v55, v52
v_fma_f32 v53, v55, v52, v53
v_rsq_f32 v53, v53
s_nop 0
v_mul_f32 v52, v52, v53
v_mul_f32 v53, -v54, v52
s_nop 0
v_mov_b32_dpp v56, v52 row_newbcast:0 row_mask:0xf bank_mask:0xf
v_mov_b32_dpp v57, v52 row_newbcast:4 row_mask:0xf bank_mask:0xf
v_mov_b32_dpp v58, v52 row_newbcast:8 row_mask:0xf bank_mask:0xf
v_mov_b32_dpp v59, v52 row_newbcast:12 row_mask:0xf bank_mask:0xf
v_mov_b32_dpp v60, v53 row_newbcast:0 row_mask:0xf bank_mask:0xf
v_mov_b32_dpp v61, v53 row_newbcast:4 row_mask:0xf bank_mask:0xf
v_mov_b32_dpp v62, v53 row_newbcast:8 row_mask:0xf bank_mask:0xf
v_mov_b32_dpp v63, v53 row_newbcast:12 row_mask:0xf bank_mask:0xf
v_pk_fma_f32 v[92:93], v[92:93], v[56:57], v[60:61]
v_pk_fma_f32 v[94:95], v[94:95], v[58:59], v[62:63]
v_pk_fma_f32 v[96:97], v[96:97], v[56:57], v[60:61]
v_pk_fma_f32 v[98:99], v[98:99], v[58:59], v[62:63]
v_pk_fma_f32 v[100:101], v[100:101], v[56:57], v[60:61]
v_pk_fma_f32 v[102:103], v[102:103], v[58:59], v[62:63]
v_pk_fma_f32 v[104:105], v[104:105], v[56:57], v[60:61]
v_pk_fma_f32 v[106:107], v[106:107], v[58:59], v[62:63]
v_pk_fma_f32 v[108:109], v[108:109], v[56:57], v[60:61]
v_pk_fma_f32 v[110:111], v[110:111], v[58:59], v[62:63]
v_cvt_pk_bf16_f32 v64, v92, v93
v_cvt_pk_bf16_f32 v65, v94, v95
v_cvt_pk_bf16_f32 v66, v96, v97
v_cvt_pk_bf16_f32 v67, v98, v99
s_nop 0
v_permlane16_swap_b32 v64, v66
v_permlane16_swap_b32 v65, v67
buffer_store_dwordx4 v[64:67], v14, s[8:11], s37 offen sc1
v_cvt_pk_bf16_f32 v68, v100, v101
v_cvt_pk_bf16_f32 v69, v102, v103
v_cvt_pk_bf16_f32 v70, v104, v105
v_cvt_pk_bf16_f32 v71, v106, v107
s_nop 0
v_permlane16_swap_b32 v68, v70
v_permlane16_swap_b32 v69, v71
s_add_u32 s99, s37, 131072
buffer_store_dwordx4 v[68:71], v14, s[8:11], s99 offen sc1
v_cvt_pk_bf16_f32 v72, v108, v109
v_cvt_pk_bf16_f32 v73, v110, v111
s_nop 0
v_permlane16_swap_b32 v72, v74
v_permlane16_swap_b32 v73, v75
s_mov_b32 exec_lo, 0xffff
s_mov_b32 exec_hi, 0xffff
s_add_u32 s99, s37, 262144
buffer_store_dwordx4 v[72:75], v14, s[8:11], s99 offen sc1
s_mov_b64 exec, -1
s_waitcnt lgkmcnt(0)
s_add_u32 m0, s50, 0
s_add_u32 s53, s49, 0
buffer_load_dwordx4 v224, s[64:67], s53 offen offset:0 lds
buffer_load_dwordx4 v225, s[64:67], s53 offen offset:1024 lds
buffer_load_dwordx4 v226, s[64:67], s53 offen offset:2048 lds
buffer_load_dwordx4 v227, s[64:67], s53 offen offset:3072 lds
s_add_u32 m0, s50, 4096
s_add_u32 s53, s49, 131072
buffer_load_dwordx4 v224, s[64:67], s53 offen offset:0 lds
buffer_load_dwordx4 v225, s[64:67], s53 offen offset:1024 lds
buffer_load_dwordx4 v226, s[64:67], s53 offen offset:2048 lds
buffer_load_dwordx4 v227, s[64:67], s53 offen offset:3072 lds
s_waitcnt vmcnt(8)
s_barrier
s_cmp_lg_u32 s20, 0
s_cbranch_scc1 mn_nf13
s_mov_b64 exec, 1
v_mov_b32 v30, s69
buffer_store_dword v30, v255, s[8:11], s6 offen sc1
s_mov_b64 exec, -1
mn_nf13:
s_add_u32 m0, s50, 8192
s_add_u32 s53, s49, 262144
buffer_load_dwordx4 v224, s[64:67], s53 offen offset:0 lds
buffer_load_dwordx4 v225, s[64:67], s53 offen offset:1024 lds
buffer_load_dwordx4 v226, s[64:67], s53 offen offset:2048 lds
buffer_load_dwordx4 v227, s[64:67], s53 offen offset:3072 lds
s_add_u32 m0, s50, 12288
s_add_u32 s53, s49, 393216
buffer_load_dwordx4 v224, s[64:67], s53 offen offset:0 lds
buffer_load_dwordx4 v225, s[64:67], s53 offen offset:1024 lds
buffer_load_dwordx4 v226, s[64:67], s53 offen offset:2048 lds
buffer_load_dwordx4 v227, s[64:67], s53 offen offset:3072 lds
s_add_u32 m0, s50, 16384
s_add_u32 s53, s49, 524288
buffer_load_dwordx4 v224, s[64:67], s53 offen offset:0 lds
buffer_load_dwordx4 v225, s[64:67], s53 offen offset:1024 lds
buffer_load_dwordx4 v226, s[64:67], s53 offen offset:2048 lds
buffer_load_dwordx4 v227, s[64:67], s53 offen offset:3072 lds
s_mov_b32 m0, s51
s_add_u32 s53, s49, 655360
buffer_load_dwordx4 v224, s[64:67], s53 offen offset:0 lds
buffer_load_dwordx4 v225, s[64:67], s53 offen offset:1024 lds
buffer_load_dwordx4 v226, s[64:67], s53 offen offset:2048 lds
buffer_load_dwordx4 v227, s[64:67], s53 offen offset:3072 lds
s_cmp_ge_u32 s2, 240
s_cbranch_scc1 mn_b1skip
s_lshl_b32 s3, s25, 6
s_add_u32 s4, s3, 63
s_mul_i32 s3, s3, 205
s_lshr_b32 s3, s3, 14
s_mul_i32 s4, s4, 205
s_lshr_b32 s4, s4, 14
s_sub_u32 s4, s4, s3
s_lshl_b32 s4, s4, 7
v_and_b32 v29, 1, v1
v_mul_u32_u24 v29, s4, v29
v_lshrrev_b32 v28, 1, v1
v_lshl_add_u32 v28, v28, 10, v29
s_lshl_b32 s3, s3, 7
s_lshl_b32 s4, s20, 13
s_add_u32 s3, s3, s4
s_add_u32 s3, s3, s27
s_add_u32 s6, s3, 12500992
s_add_u32 s3, s20, 0
s_and_b32 s3, s3, 3
s_lshl_b32 s4, s25, 2
s_add_u32 s3, s3, s4
s_lshl_b32 s3, s3, 16
s_lshl_b32 s4, s20, 14
s_add_u32 s3, s3, s4
s_add_u32 s3, s3, s27
s_add_u32 s30, s3, 5242880
s_add_u32 s3, s20, 1
s_and_b32 s3, s3, 3
s_lshl_b32 s4, s25, 2
s_add_u32 s3, s3, s4
s_lshl_b32 s3, s3, 16
s_lshl_b32 s4, s20, 14
s_add_u32 s3, s3, s4
s_add_u32 s3, s3, s27
s_add_u32 s31, s3, 5242880
s_add_u32 s3, s20, 2
s_and_b32 s3, s3, 3
s_lshl_b32 s4, s25, 2
s_add_u32 s3, s3, s4
s_lshl_b32 s3, s3, 16
s_lshl_b32 s4, s20, 14
s_add_u32 s3, s3, s4
s_add_u32 s3, s3, s27
s_add_u32 s32, s3, 5242880
s_add_u32 s3, s20, 3
s_and_b32 s3, s3, 3
s_lshl_b32 s4, s25, 2
s_add_u32 s3, s3, s4
s_lshl_b32 s3, s3, 16
s_lshl_b32 s4, s20, 14
s_add_u32 s3, s3, s4
s_add_u32 s3, s3, s27
s_add_u32 s33, s3, 5242880
v_lshlrev_b32 v20, 3, v5
s_lshl_b32 s7, s26, 7
buffer_load_dwordx2 v[12:13], v20, s[12:15], s7 offen offset:0
buffer_load_dwordx2 v[14:15], v20, s[12:15], s7 offen offset:32
buffer_load_dwordx2 v[16:17], v20, s[12:15], s7 offen offset:64
buffer_load_dwordx2 v[18:19], v20, s[12:15], s7 offen offset:96
s_add_u32 s3, s20, 1
s_and_b32 s3, s3, 3
s_lshr_b32 s4, s3, 1
s_mul_i32 s4, s4, 92160
s_mul_i32 s3, s3, 15360
s_add_u32 s3, s3, 0
s_add_u32 s3, s3, s4
v_add_u32 v8, s3, v2
s_add_u32 s3, s20, 2
s_and_b32 s3, s3, 3
s_lshr_b32 s4, s3, 1
s_mul_i32 s4, s4, 92160
s_mul_i32 s3, s3, 15360
s_add_u32 s3, s3, 5120
s_add_u32 s3, s3, s4
v_add_u32 v9, s3, v2
s_add_u32 s3, s20, 3
s_and_b32 s3, s3, 3
s_lshr_b32 s4, s3, 1
s_mul_i32 s4, s4, 92160
s_mul_i32 s3, s3, 15360
s_add_u32 s3, s3, 10240
s_add_u32 s3, s3, s4
v_add_u32 v10, s3, v2
s_add_u32 s3, s20, 0
s_and_b32 s3, s3, 3
s_lshr_b32 s4, s3, 1
s_mul_i32 s4, s4, 92160
s_mul_i32 s3, s3, 15360
s_add_u32 s3, s3, 0
s_add_u32 s3, s3, s4
v_add_u32 v11, s3, v2
s_mov_b64 exec, 0xffff
s_mov_b32 s5, 262144
mn_poll14:
buffer_load_dword v29, v28, s[8:11], s6 offen sc1
s_sub_u32 s5, s5, 1
s_cbranch_scc1 mn_pout15
s_waitcnt vmcnt(0)
v_cmpx_ne_u32 vcc, s69, v29
s_cbranch_execnz mn_poll14
mn_pout15:
s_waitcnt vmcnt(0)
s_mov_b64 exec, -1
s_nop 3
buffer_load_dwordx4 v[96:99], v2, s[8:11], s30 offen offset:0 sc1
buffer_load_dwordx4 v[100:103], v2, s[8:11], s31 offen offset:0 sc1
buffer_load_dwordx4 v[104:107], v2, s[8:11], s32 offen offset:0 sc1
buffer_load_dwordx4 v[108:111], v2, s[8:11], s33 offen offset:0 sc1
buffer_load_dwordx4 v[112:115], v2, s[8:11], s30 offen offset:1024 sc1
buffer_load_dwordx4 v[116:119], v2, s[8:11], s31 offen offset:1024 sc1
buffer_load_dwordx4 v[120:123], v2, s[8:11], s32 offen offset:1024 sc1
buffer_load_dwordx4 v[124:127], v2, s[8:11], s33 offen offset:1024 sc1
buffer_load_dwordx4 v[128:131], v2, s[8:11], s30 offen offset:2048 sc1
buffer_load_dwordx4 v[132:135], v2, s[8:11], s31 offen offset:2048 sc1
buffer_load_dwordx4 v[136:139], v2, s[8:11], s32 offen offset:2048 sc1
buffer_load_dwordx4 v[140:143], v2, s[8:11], s33 offen offset:2048 sc1
s_waitcnt vmcnt(11)
v_mfma_f32_16x16x32_bf16 v[32:35], a[0:3], v[96:99], 0
buffer_load_dwordx4 v[144:147], v2, s[8:11], s30 offen offset:3072 sc1
v_mfma_f32_16x16x32_bf16 v[36:39], a[4:7], v[96:99], 0
v_mfma_f32_16x16x32_bf16 v[40:43], a[8:11], v[96:99], 0
buffer_load_dwordx4 v[148:151], v2, s[8:11], s31 offen offset:3072 sc1
v_mfma_f32_16x16x32_bf16 v[44:47], a[12:15], v[96:99], 0
s_waitcnt vmcnt(12)
v_mfma_f32_16x16x32_bf16 v[48:51], a[0:3], v[100:103], 0
buffer_load_dwordx4 v[152:155], v2, s[8:11], s32 offen offset:3072 sc1
v_mfma_f32_16x16x32_bf16 v[52:55], a[4:7], v[100:103], 0
v_mfma_f32_16x16x32_bf16 v[56:59], a[8:11], v[100:103], 0
buffer_load_dwordx4 v[156:159], v2, s[8:11], s33 offen offset:3072 sc1
v_mfma_f32_16x16x32_bf16 v[60:63], a[12:15], v[100:103], 0
s_waitcnt vmcnt(13)
v_mfma_f32_16x16x32_bf16 v[64:67], a[0:3], v[104:107], 0
s_add_u32 s30, s30, 4096
buffer_load_dwordx4 v[160:163], v2, s[8:11], s30 offen offset:0 sc1
v_mfma_f32_16x16x32_bf16 v[68:71], a[4:7], v[104:107], 0
v_mfma_f32_16x16x32_bf16 v[72:75], a[8:11], v[104:107], 0
s_add_u32 s31, s31, 4096
buffer_load_dwordx4 v[164:167], v2, s[8:11], s31 offen offset:0 sc1
v_mfma_f32_16x16x32_bf16 v[76:79], a[12:15], v[104:107], 0
s_waitcnt vmcnt(14)
v_mfma_f32_16x16x32_bf16 v[80:83], a[0:3], v[108:111], 0
s_add_u32 s32, s32, 4096
buffer_load_dwordx4 v[168:171], v2, s[8:11], s32 offen offset:0 sc1
v_mfma_f32_16x16x32_bf16 v[84:87], a[4:7], v[108:111], 0
v_mfma_f32_16x16x32_bf16 v[88:91], a[8:11], v[108:111], 0
s_add_u32 s33, s33, 4096
buffer_load_dwordx4 v[172:175], v2, s[8:11], s33 offen offset:0 sc1
v_mfma_f32_16x16x32_bf16 v[92:95], a[12:15], v[108:111], 0
s_waitcnt vmcnt(15)
v_mfma_f32_16x16x32_bf16 v[32:35], a[16:19], v[112:115], v[32:35]
buffer_load_dwordx4 v[176:179], v2, s[8:11], s30 offen offset:1024 sc1
v_mfma_f32_16x16x32_bf16 v[36:39], a[20:23], v[112:115], v[36:39]
ds_read_b64_tr_b16 a[0:1], v216 offset:0
v_mfma_f32_16x16x32_bf16 v[40:43], a[24:27], v[112:115], v[40:43]
buffer_load_dwordx4 v[180:183], v2, s[8:11], s31 offen offset:1024 sc1
v_mfma_f32_16x16x32_bf16 v[44:47], a[28:31], v[112:115], v[44:47]
ds_read_b64_tr_b16 a[2:3], v216 offset:2048
s_waitcnt vmcnt(16)
v_mfma_f32_16x16x32_bf16 v[48:51], a[16:19], v[116:119], v[48:51]
buffer_load_dwordx4 v[184:187], v2, s[8:11], s32 offen offset:1024 sc1
v_mfma_f32_16x16x32_bf16 v[52:55], a[20:23], v[116:119], v[52:55]
ds_read_b64_tr_b16 a[4:5], v217 offset:0
v_mfma_f32_16x16x32_bf16 v[56:59], a[24:27], v[116:119], v[56:59]
buffer_load_dwordx4 v[188:191], v2, s[8:11], s33 offen offset:1024 sc1
v_mfma_f32_16x16x32_bf16 v[60:63], a[28:31], v[116:119], v[60:63]
ds_read_b64_tr_b16 a[6:7], v217 offset:2048
s_waitcnt vmcnt(17)
v_mfma_f32_16x16x32_bf16 v[64:67], a[16:19], v[120:123], v[64:67]
buffer_load_dwordx4 v[192:195], v2, s[8:11], s30 offen offset:2048 sc1
v_mfma_f32_16x16x32_bf16 v[68:71], a[20:23], v[120:123], v[68:71]
ds_read_b64_tr_b16 a[8:9], v218 offset:0
v_mfma_f32_16x16x32_bf16 v[72:75], a[24:27], v[120:123], v[72:75]
buffer_load_dwordx4 v[196:199], v2, s[8:11], s31 offen offset:2048 sc1
v_mfma_f32_16x16x32_bf16 v[76:79], a[28:31], v[120:123], v[76:79]
ds_read_b64_tr_b16 a[10:11], v218 offset:2048
s_waitcnt vmcnt(18)
v_mfma_f32_16x16x32_bf16 v[80:83], a[16:19], v[124:127], v[80:83]
buffer_load_dwordx4 v[200:203], v2, s[8:11], s32 offen offset:2048 sc1
v_mfma_f32_16x16x32_bf16 v[84:87], a[20:23], v[124:127], v[84:87]
ds_read_b64_tr_b16 a[12:13], v219 offset:0
v_mfma_f32_16x16x32_bf16 v[88:91], a[24:27], v[124:127], v[88:91]
buffer_load_dwordx4 v[204:207], v2, s[8:11], s33 offen offset:2048 sc1
v_mfma_f32_16x16x32_bf16 v[92:95], a[28:31], v[124:127], v[92:95]
ds_read_b64_tr_b16 a[14:15], v219 offset:2048
s_waitcnt lgkmcnt(8)
s_waitcnt vmcnt(19)
v_mfma_f32_16x16x32_bf16 v[32:35], a[32:35], v[128:131], v[32:35]
buffer_load_dwordx4 v[96:99], v2, s[8:11], s30 offen offset:3072 sc1
v_mfma_f32_16x16x32_bf16 v[36:39], a[36:39], v[128:131], v[36:39]
ds_read_b64_tr_b16 a[16:17], v216 offset:4096
v_mfma_f32_16x16x32_bf16 v[40:43], a[40:43], v[128:131], v[40:43]
buffer_load_dwordx4 v[100:103], v2, s[8:11], s31 offen offset:3072 sc1
v_mfma_f32_16x16x32_bf16 v[44:47], a[44:47], v[128:131], v[44:47]
ds_read_b64_tr_b16 a[18:19], v216 offset:6144
s_waitcnt vmcnt(20)
v_mfma_f32_16x16x32_bf16 v[48:51], a[32:35], v[132:135], v[48:51]
buffer_load_dwordx4 v[104:107], v2, s[8:11], s32 offen offset:3072 sc1
v_mfma_f32_16x16x32_bf16 v[52:55], a[36:39], v[132:135], v[52:55]
ds_read_b64_tr_b16 a[20:21], v217 offset:4096
v_mfma_f32_16x16x32_bf16 v[56:59], a[40:43], v[132:135], v[56:59]
buffer_load_dwordx4 v[108:111], v2, s[8:11], s33 offen offset:3072 sc1
v_mfma_f32_16x16x32_bf16 v[60:63], a[44:47], v[132:135], v[60:63]
ds_read_b64_tr_b16 a[22:23], v217 offset:6144
s_waitcnt vmcnt(21)
v_mfma_f32_16x16x32_bf16 v[64:67], a[32:35], v[136:139], v[64:67]
s_add_u32 s30, s30, 4096
buffer_load_dwordx4 v[112:115], v2, s[8:11], s30 offen offset:0 sc1
v_mfma_f32_16x16x32_bf16 v[68:71], a[36:39], v[136:139], v[68:71]
ds_read_b64_tr_b16 a[24:25], v218 offset:4096
v_mfma_f32_16x16x32_bf16 v[72:75], a[40:43], v[136:139], v[72:75]
s_add_u32 s31, s31, 4096
buffer_load_dwordx4 v[116:119], v2, s[8:11], s31 offen offset:0 sc1
v_mfma_f32_16x16x32_bf16 v[76:79], a[44:47], v[136:139], v[76:79]
ds_read_b64_tr_b16 a[26:27], v218 offset:6144
s_waitcnt vmcnt(22)
v_mfma_f32_16x16x32_bf16 v[80:83], a[32:35], v[140:143], v[80:83]
s_add_u32 s32, s32, 4096
buffer_load_dwordx4 v[120:123], v2, s[8:11], s32 offen offset:0 sc1
v_mfma_f32_16x16x32_bf16 v[84:87], a[36:39], v[140:143], v[84:87]
ds_read_b64_tr_b16 a[28:29], v219 offset:4096
v_mfma_f32_16x16x32_bf16 v[88:91], a[40:43], v[140:143], v[88:91]
s_add_u32 s33, s33, 4096
buffer_load_dwordx4 v[124:127], v2, s[8:11], s33 offen offset:0 sc1
v_mfma_f32_16x16x32_bf16 v[92:95], a[44:47], v[140:143], v[92:95]
ds_read_b64_tr_b16 a[30:31], v219 offset:6144
s_waitcnt lgkmcnt(8)
s_waitcnt vmcnt(23)
v_mfma_f32_16x16x32_bf16 v[32:35], a[48:51], v[144:147], v[32:35]
buffer_load_dwordx4 v[128:131], v2, s[8:11], s30 offen offset:1024 sc1
v_mfma_f32_16x16x32_bf16 v[36:39], a[52:55], v[144:147], v[36:39]
ds_read_b64_tr_b16 a[32:33], v216 offset:8192
v_mfma_f32_16x16x32_bf16 v[40:43], a[56:59], v[144:147], v[40:43]
buffer_load_dwordx4 v[132:135], v2, s[8:11], s31 offen offset:1024 sc1
v_mfma_f32_16x16x32_bf16 v[44:47], a[60:63], v[144:147], v[44:47]
ds_read_b64_tr_b16 a[34:35], v216 offset:10240
s_waitcnt vmcnt(24)
v_mfma_f32_16x16x32_bf16 v[48:51], a[48:51], v[148:151], v[48:51]
buffer_load_dwordx4 v[136:139], v2, s[8:11], s32 offen offset:1024 sc1
v_mfma_f32_16x16x32_bf16 v[52:55], a[52:55], v[148:151], v[52:55]
ds_read_b64_tr_b16 a[36:37], v217 offset:8192
v_mfma_f32_16x16x32_bf16 v[56:59], a[56:59], v[148:151], v[56:59]
buffer_load_dwordx4 v[140:143], v2, s[8:11], s33 offen offset:1024 sc1
v_mfma_f32_16x16x32_bf16 v[60:63], a[60:63], v[148:151], v[60:63]
ds_read_b64_tr_b16 a[38:39], v217 offset:10240
s_waitcnt vmcnt(25)
v_mfma_f32_16x16x32_bf16 v[64:67], a[48:51], v[152:155], v[64:67]
buffer_load_dwordx4 v[144:147], v2, s[8:11], s30 offen offset:2048 sc1
v_mfma_f32_16x16x32_bf16 v[68:71], a[52:55], v[152:155], v[68:71]
ds_read_b64_tr_b16 a[40:41], v218 offset:8192
v_mfma_f32_16x16x32_bf16 v[72:75], a[56:59], v[152:155], v[72:75]
buffer_load_dwordx4 v[148:151], v2, s[8:11], s31 offen offset:2048 sc1
v_mfma_f32_16x16x32_bf16 v[76:79], a[60:63], v[152:155], v[76:79]
ds_read_b64_tr_b16 a[42:43], v218 offset:10240
s_waitcnt vmcnt(26)
v_mfma_f32_16x16x32_bf16 v[80:83], a[48:51], v[156:159], v[80:83]
buffer_load_dwordx4 v[152:155], v2, s[8:11], s32 offen offset:2048 sc1
v_mfma_f32_16x16x32_bf16 v[84:87], a[52:55], v[156:159], v[84:87]
ds_read_b64_tr_b16 a[44:45], v219 offset:8192
v_mfma_f32_16x16x32_bf16 v[88:91], a[56:59], v[156:159], v[88:91]
v_mfma_f32_16x16x32_bf16 v[92:95], a[60:63], v[156:159], v[92:95]
ds_read_b64_tr_b16 a[46:47], v219 offset:10240
s_waitcnt lgkmcnt(8)
s_waitcnt vmcnt(26)
v_mfma_f32_16x16x32_bf16 v[32:35], a[64:67], v[160:163], v[32:35]
buffer_load_dwordx4 v[156:159], v2, s[8:11], s33 offen offset:2048 sc1
v_mfma_f32_16x16x32_bf16 v[36:39], a[68:71], v[160:163], v[36:39]
ds_read_b64_tr_b16 a[48:49], v216 offset:12288
v_mfma_f32_16x16x32_bf16 v[40:43], a[72:75], v[160:163], v[40:43]
v_mfma_f32_16x16x32_bf16 v[44:47], a[76:79], v[160:163], v[44:47]
ds_read_b64_tr_b16 a[50:51], v216 offset:14336
s_waitcnt vmcnt(26)
v_mfma_f32_16x16x32_bf16 v[48:51], a[64:67], v[164:167], v[48:51]
buffer_load_dwordx4 v[160:163], v2, s[8:11], s30 offen offset:3072 sc1
v_mfma_f32_16x16x32_bf16 v[52:55], a[68:71], v[164:167], v[52:55]
ds_read_b64_tr_b16 a[52:53], v217 offset:12288
v_mfma_f32_16x16x32_bf16 v[56:59], a[72:75], v[164:167], v[56:59]
v_mfma_f32_16x16x32_bf16 v[60:63], a[76:79], v[164:167], v[60:63]
ds_read_b64_tr_b16 a[54:55], v217 offset:14336
s_waitcnt vmcnt(26)
v_mfma_f32_16x16x32_bf16 v[64:67], a[64:67], v[168:171], v[64:67]
buffer_load_dwordx4 v[164:167], v2, s[8:11], s31 offen offset:3072 sc1
v_mfma_f32_16x16x32_bf16 v[68:71], a[68:71], v[168:171], v[68:71]
ds_read_b64_tr_b16 a[56:57], v218 offset:12288
v_mfma_f32_16x16x32_bf16 v[72:75], a[72:75], v[168:171], v[72:75]
v_mfma_f32_16x16x32_bf16 v[76:79], a[76:79], v[168:171], v[76:79]
ds_read_b64_tr_b16 a[58:59], v218 offset:14336
s_waitcnt vmcnt(26)
v_mfma_f32_16x16x32_bf16 v[80:83], a[64:67], v[172:175], v[80:83]
buffer_load_dwordx4 v[168:171], v2, s[8:11], s32 offen offset:3072 sc1
v_mfma_f32_16x16x32_bf16 v[84:87], a[68:71], v[172:175], v[84:87]
ds_read_b64_tr_b16 a[60:61], v219 offset:12288
v_mfma_f32_16x16x32_bf16 v[88:91], a[72:75], v[172:175], v[88:91]
v_mfma_f32_16x16x32_bf16 v[92:95], a[76:79], v[172:175], v[92:95]
ds_read_b64_tr_b16 a[62:63], v219 offset:14336
s_waitcnt lgkmcnt(8)
s_waitcnt vmcnt(26)
v_mfma_f32_16x16x32_bf16 v[32:35], a[80:83], v[176:179], v[32:35]
buffer_load_dwordx4 v[172:175], v2, s[8:11], s33 offen offset:3072 sc1
v_mfma_f32_16x16x32_bf16 v[36:39], a[84:87], v[176:179], v[36:39]
ds_read_b64_tr_b16 a[64:65], v216 offset:16384
v_mfma_f32_16x16x32_bf16 v[40:43], a[88:91], v[176:179], v[40:43]
v_mfma_f32_16x16x32_bf16 v[44:47], a[92:95], v[176:179], v[44:47]
ds_read_b64_tr_b16 a[66:67], v216 offset:18432
s_waitcnt vmcnt(26)
v_mfma_f32_16x16x32_bf16 v[48:51], a[80:83], v[180:183], v[48:51]
s_add_u32 s30, s30, 4096
buffer_load_dwordx4 v[176:179], v2, s[8:11], s30 offen offset:0 sc1
v_mfma_f32_16x16x32_bf16 v[52:55], a[84:87], v[180:183], v[52:55]
ds_read_b64_tr_b16 a[68:69], v217 offset:16384
v_mfma_f32_16x16x32_bf16 v[56:59], a[88:91], v[180:183], v[56:59]
v_mfma_f32_16x16x32_bf16 v[60:63], a[92:95], v[180:183], v[60:63]
ds_read_b64_tr_b16 a[70:71], v217 offset:18432
s_waitcnt vmcnt(26)
v_mfma_f32_16x16x32_bf16 v[64:67], a[80:83], v[184:187], v[64:67]
s_add_u32 s31, s31, 4096
buffer_load_dwordx4 v[180:183], v2, s[8:11], s31 offen offset:0 sc1
v_mfma_f32_16x16x32_bf16 v[68:71], a[84:87], v[184:187], v[68:71]
ds_read_b64_tr_b16 a[72:73], v218 offset:16384
v_mfma_f32_16x16x32_bf16 v[72:75], a[88:91], v[184:187], v[72:75]
v_mfma_f32_16x16x32_bf16 v[76:79], a[92:95], v[184:187], v[76:79]
ds_read_b64_tr_b16 a[74:75], v218 offset:18432
s_waitcnt vmcnt(26)
v_mfma_f32_16x16x32_bf16 v[80:83], a[80:83], v[188:191], v[80:83]
s_add_u32 s32, s32, 4096
buffer_load_dwordx4 v[184:187], v2, s[8:11], s32 offen offset:0 sc1
v_mfma_f32_16x16x32_bf16 v[84:87], a[84:87], v[188:191], v[84:87]
ds_read_b64_tr_b16 a[76:77], v219 offset:16384
v_mfma_f32_16x16x32_bf16 v[88:91], a[88:91], v[188:191], v[88:91]
v_mfma_f32_16x16x32_bf16 v[92:95], a[92:95], v[188:191], v[92:95]
ds_read_b64_tr_b16 a[78:79], v219 offset:18432
s_waitcnt lgkmcnt(8)
s_waitcnt vmcnt(26)
v_mfma_f32_16x16x32_bf16 v[32:35], a[96:99], v[192:195], v[32:35]
s_add_u32 s33, s33, 4096
buffer_load_dwordx4 v[188:191], v2, s[8:11], s33 offen offset:0 sc1
v_mfma_f32_16x16x32_bf16 v[36:39], a[100:103], v[192:195], v[36:39]
ds_read_b64_tr_b16 a[80:81], v220 offset:0
v_mfma_f32_16x16x32_bf16 v[40:43], a[104:107], v[192:195], v[40:43]
v_mfma_f32_16x16x32_bf16 v[44:47], a[108:111], v[192:195], v[44:47]
ds_read_b64_tr_b16 a[82:83], v220 offset:2048
s_waitcnt vmcnt(26)
v_mfma_f32_16x16x32_bf16 v[48:51], a[96:99], v[196:199], v[48:51]
buffer_load_dwordx4 v[192:195], v2, s[8:11], s30 offen offset:1024 sc1
v_mfma_f32_16x16x32_bf16 v[52:55], a[100:103], v[196:199], v[52:55]
ds_read_b64_tr_b16 a[84:85], v221 offset:0
v_mfma_f32_16x16x32_bf16 v[56:59], a[104:107], v[196:199], v[56:59]
v_mfma_f32_16x16x32_bf16 v[60:63], a[108:111], v[196:199], v[60:63]
ds_read_b64_tr_b16 a[86:87], v221 offset:2048
s_waitcnt vmcnt(26)
v_mfma_f32_16x16x32_bf16 v[64:67], a[96:99], v[200:203], v[64:67]
buffer_load_dwordx4 v[196:199], v2, s[8:11], s31 offen offset:1024 sc1
v_mfma_f32_16x16x32_bf16 v[68:71], a[100:103], v[200:203], v[68:71]
ds_read_b64_tr_b16 a[88:89], v222 offset:0
v_mfma_f32_16x16x32_bf16 v[72:75], a[104:107], v[200:203], v[72:75]
v_mfma_f32_16x16x32_bf16 v[76:79], a[108:111], v[200:203], v[76:79]
ds_read_b64_tr_b16 a[90:91], v222 offset:2048
s_waitcnt vmcnt(26)
v_mfma_f32_16x16x32_bf16 v[80:83], a[96:99], v[204:207], v[80:83]
buffer_load_dwordx4 v[200:203], v2, s[8:11], s32 offen offset:1024 sc1
v_mfma_f32_16x16x32_bf16 v[84:87], a[100:103], v[204:207], v[84:87]
ds_read_b64_tr_b16 a[92:93], v223 offset:0
v_mfma_f32_16x16x32_bf16 v[88:91], a[104:107], v[204:207], v[88:91]
v_mfma_f32_16x16x32_bf16 v[92:95], a[108:111], v[204:207], v[92:95]
ds_read_b64_tr_b16 a[94:95], v223 offset:2048
s_waitcnt lgkmcnt(8)
s_waitcnt vmcnt(26)
v_mfma_f32_16x16x32_bf16 v[32:35], a[112:115], v[96:99], v[32:35]
buffer_load_dwordx4 v[204:207], v2, s[8:11], s33 offen offset:1024 sc1
v_mfma_f32_16x16x32_bf16 v[36:39], a[116:119], v[96:99], v[36:39]
v_mfma_f32_16x16x32_bf16 v[40:43], a[120:123], v[96:99], v[40:43]
v_mfma_f32_16x16x32_bf16 v[44:47], a[124:127], v[96:99], v[44:47]
s_waitcnt vmcnt(26)
v_mfma_f32_16x16x32_bf16 v[48:51], a[112:115], v[100:103], v[48:51]
buffer_load_dwordx4 v[96:99], v2, s[8:11], s30 offen offset:2048 sc1
v_mfma_f32_16x16x32_bf16 v[52:55], a[116:119], v[100:103], v[52:55]
v_mfma_f32_16x16x32_bf16 v[56:59], a[120:123], v[100:103], v[56:59]
v_mfma_f32_16x16x32_bf16 v[60:63], a[124:127], v[100:103], v[60:63]
s_waitcnt vmcnt(26)
v_mfma_f32_16x16x32_bf16 v[64:67], a[112:115], v[104:107], v[64:67]
buffer_load_dwordx4 v[100:103], v2, s[8:11], s31 offen offset:2048 sc1
v_mfma_f32_16x16x32_bf16 v[68:71], a[116:119], v[104:107], v[68:71]
v_mfma_f32_16x16x32_bf16 v[72:75], a[120:123], v[104:107], v[72:75]
v_mfma_f32_16x16x32_bf16 v[76:79], a[124:127], v[104:107], v[76:79]
s_waitcnt vmcnt(26)
v_mfma_f32_16x16x32_bf16 v[80:83], a[112:115], v[108:111], v[80:83]
buffer_load_dwordx4 v[104:107], v2, s[8:11], s32 offen offset:2048 sc1
v_mfma_f32_16x16x32_bf16 v[84:87], a[116:119], v[108:111], v[84:87]
v_mfma_f32_16x16x32_bf16 v[88:91], a[120:123], v[108:111], v[88:91]
v_mfma_f32_16x16x32_bf16 v[92:95], a[124:127], v[108:111], v[92:95]
s_waitcnt vmcnt(26)
v_mfma_f32_16x16x32_bf16 v[32:35], a[128:131], v[112:115], v[32:35]
buffer_load_dwordx4 v[108:111], v2, s[8:11], s33 offen offset:2048 sc1
v_mfma_f32_16x16x32_bf16 v[36:39], a[132:135], v[112:115], v[36:39]
v_mfma_f32_16x16x32_bf16 v[40:43], a[136:139], v[112:115], v[40:43]
s_waitcnt lgkmcnt(0)
v_mfma_f32_16x16x32_bf16 v[44:47], a[140:143], v[112:115], v[44:47]
s_waitcnt vmcnt(26)
v_mfma_f32_16x16x32_bf16 v[48:51], a[128:131], v[116:119], v[48:51]
buffer_load_dwordx4 v[112:115], v2, s[8:11], s30 offen offset:3072 sc1
v_mfma_f32_16x16x32_bf16 v[52:55], a[132:135], v[116:119], v[52:55]
v_mfma_f32_16x16x32_bf16 v[56:59], a[136:139], v[116:119], v[56:59]
v_mfma_f32_16x16x32_bf16 v[60:63], a[140:143], v[116:119], v[60:63]
s_waitcnt vmcnt(26)
v_mfma_f32_16x16x32_bf16 v[64:67], a[128:131], v[120:123], v[64:67]
buffer_load_dwordx4 v[116:119], v2, s[8:11], s31 offen offset:3072 sc1
v_mfma_f32_16x16x32_bf16 v[68:71], a[132:135], v[120:123], v[68:71]
v_mfma_f32_16x16x32_bf16 v[72:75], a[136:139], v[120:123], v[72:75]
v_mfma_f32_16x16x32_bf16 v[76:79], a[140:143], v[120:123], v[76:79]
s_waitcnt vmcnt(26)
v_mfma_f32_16x16x32_bf16 v[80:83], a[128:131], v[124:127], v[80:83]
buffer_load_dwordx4 v[120:123], v2, s[8:11], s32 offen offset:3072 sc1
v_mfma_f32_16x16x32_bf16 v[84:87], a[132:135], v[124:127], v[84:87]
v_mfma_f32_16x16x32_bf16 v[88:91], a[136:139], v[124:127], v[88:91]
v_mfma_f32_16x16x32_bf16 v[92:95], a[140:143], v[124:127], v[92:95]
s_waitcnt vmcnt(26)
v_mfma_f32_16x16x32_bf16 v[32:35], a[144:147], v[128:131], v[32:35]
buffer_load_dwordx4 v[124:127], v2, s[8:11], s33 offen offset:3072 sc1
v_mfma_f32_16x16x32_bf16 v[36:39], a[148:151], v[128:131], v[36:39]
v_mfma_f32_16x16x32_bf16 v[40:43], a[152:155], v[128:131], v[40:43]
v_mfma_f32_16x16x32_bf16 v[44:47], a[156:159], v[128:131], v[44:47]
s_waitcnt vmcnt(26)
v_mfma_f32_16x16x32_bf16 v[48:51], a[144:147], v[132:135], v[48:51]
v_mfma_f32_16x16x32_bf16 v[52:55], a[148:151], v[132:135], v[52:55]
v_mfma_f32_16x16x32_bf16 v[56:59], a[152:155], v[132:135], v[56:59]
v_mfma_f32_16x16x32_bf16 v[60:63], a[156:159], v[132:135], v[60:63]
s_waitcnt vmcnt(25)
v_mfma_f32_16x16x32_bf16 v[64:67], a[144:147], v[136:139], v[64:67]
v_mfma_f32_16x16x32_bf16 v[68:71], a[148:151], v[136:139], v[68:71]
v_mfma_f32_16x16x32_bf16 v[72:75], a[152:155], v[136:139], v[72:75]
v_mfma_f32_16x16x32_bf16 v[76:79], a[156:159], v[136:139], v[76:79]
s_waitcnt vmcnt(24)
v_mfma_f32_16x16x32_bf16 v[80:83], a[144:147], v[140:143], v[80:83]
v_mfma_f32_16x16x32_bf16 v[84:87], a[148:151], v[140:143], v[84:87]
v_mfma_f32_16x16x32_bf16 v[88:91], a[152:155], v[140:143], v[88:91]
v_mfma_f32_16x16x32_bf16 v[92:95], a[156:159], v[140:143], v[92:95]
s_waitcnt vmcnt(23)
v_mfma_f32_16x16x32_bf16 v[32:35], a[160:163], v[144:147], v[32:35]
v_mfma_f32_16x16x32_bf16 v[36:39], a[164:167], v[144:147], v[36:39]
v_mfma_f32_16x16x32_bf16 v[40:43], a[168:171], v[144:147], v[40:43]
v_mfma_f32_16x16x32_bf16 v[44:47], a[172:175], v[144:147], v[44:47]
s_waitcnt vmcnt(22)
v_mfma_f32_16x16x32_bf16 v[48:51], a[160:163], v[148:151], v[48:51]
v_mfma_f32_16x16x32_bf16 v[52:55], a[164:167], v[148:151], v[52:55]
v_mfma_f32_16x16x32_bf16 v[56:59], a[168:171], v[148:151], v[56:59]
v_mfma_f32_16x16x32_bf16 v[60:63], a[172:175], v[148:151], v[60:63]
s_waitcnt vmcnt(21)
v_mfma_f32_16x16x32_bf16 v[64:67], a[160:163], v[152:155], v[64:67]
v_mfma_f32_16x16x32_bf16 v[68:71], a[164:167], v[152:155], v[68:71]
v_mfma_f32_16x16x32_bf16 v[72:75], a[168:171], v[152:155], v[72:75]
v_mfma_f32_16x16x32_bf16 v[76:79], a[172:175], v[152:155], v[76:79]
s_waitcnt vmcnt(20)
v_mfma_f32_16x16x32_bf16 v[80:83], a[160:163], v[156:159], v[80:83]
v_mfma_f32_16x16x32_bf16 v[84:87], a[164:167], v[156:159], v[84:87]
v_mfma_f32_16x16x32_bf16 v[88:91], a[168:171], v[156:159], v[88:91]
v_mfma_f32_16x16x32_bf16 v[92:95], a[172:175], v[156:159], v[92:95]
s_waitcnt vmcnt(19)
v_mfma_f32_16x16x32_bf16 v[32:35], a[176:179], v[160:163], v[32:35]
v_mfma_f32_16x16x32_bf16 v[36:39], a[180:183], v[160:163], v[36:39]
v_mfma_f32_16x16x32_bf16 v[40:43], a[184:187], v[160:163], v[40:43]
v_mfma_f32_16x16x32_bf16 v[44:47], a[188:191], v[160:163], v[44:47]
s_waitcnt vmcnt(18)
v_mfma_f32_16x16x32_bf16 v[48:51], a[176:179], v[164:167], v[48:51]
v_mfma_f32_16x16x32_bf16 v[52:55], a[180:183], v[164:167], v[52:55]
v_mfma_f32_16x16x32_bf16 v[56:59], a[184:187], v[164:167], v[56:59]
v_mfma_f32_16x16x32_bf16 v[60:63], a[188:191], v[164:167], v[60:63]
s_waitcnt vmcnt(17)
v_mfma_f32_16x16x32_bf16 v[64:67], a[176:179], v[168:171], v[64:67]
v_mfma_f32_16x16x32_bf16 v[68:71], a[180:183], v[168:171], v[68:71]
v_mfma_f32_16x16x32_bf16 v[72:75], a[184:187], v[168:171], v[72:75]
v_mfma_f32_16x16x32_bf16 v[76:79], a[188:191], v[168:171], v[76:79]
s_waitcnt vmcnt(16)
v_mfma_f32_16x16x32_bf16 v[80:83], a[176:179], v[172:175], v[80:83]
v_mfma_f32_16x16x32_bf16 v[84:87], a[180:183], v[172:175], v[84:87]
v_mfma_f32_16x16x32_bf16 v[88:91], a[184:187], v[172:175], v[88:91]
v_mfma_f32_16x16x32_bf16 v[92:95], a[188:191], v[172:175], v[92:95]
s_waitcnt vmcnt(15)
v_mfma_f32_16x16x32_bf16 v[32:35], a[192:195], v[176:179], v[32:35]
v_mfma_f32_16x16x32_bf16 v[36:39], a[196:199], v[176:179], v[36:39]
v_mfma_f32_16x16x32_bf16 v[40:43], a[200:203], v[176:179], v[40:43]
v_mfma_f32_16x16x32_bf16 v[44:47], a[204:207], v[176:179], v[44:47]
s_waitcnt vmcnt(14)
v_mfma_f32_16x16x32_bf16 v[48:51], a[192:195], v[180:183], v[48:51]
v_mfma_f32_16x16x32_bf16 v[52:55], a[196:199], v[180:183], v[52:55]
v_mfma_f32_16x16x32_bf16 v[56:59], a[200:203], v[180:183], v[56:59]
v_mfma_f32_16x16x32_bf16 v[60:63], a[204:207], v[180:183], v[60:63]
s_waitcnt vmcnt(13)
v_mfma_f32_16x16x32_bf16 v[64:67], a[192:195], v[184:187], v[64:67]
v_mfma_f32_16x16x32_bf16 v[68:71], a[196:199], v[184:187], v[68:71]
s_mov_b32 s36, 0xbdd2d3e8
v_mfma_f32_16x16x32_bf16 v[72:75], a[200:203], v[184:187], v[72:75]
v_mfma_f32_16x16x32_bf16 v[76:79], a[204:207], v[184:187], v[76:79]
s_waitcnt vmcnt(12)
v_mfma_f32_16x16x32_bf16 v[80:83], a[192:195], v[188:191], v[80:83]
v_mfma_f32_16x16x32_bf16 v[84:87], a[196:199], v[188:191], v[84:87]
v_mov_b32 v28, 0xc0135761
v_mfma_f32_16x16x32_bf16 v[88:91], a[200:203], v[188:191], v[88:91]
v_mfma_f32_16x16x32_bf16 v[92:95], a[204:207], v[188:191], v[92:95]
s_waitcnt vmcnt(11)
v_mfma_f32_16x16x32_bf16 v[32:35], a[208:211], v[192:195], v[32:35]
v_mfma_f32_16x16x32_bf16 v[36:39], a[212:215], v[192:195], v[36:39]
s_mov_b32 s37, 0xffff0000
v_mfma_f32_16x16x32_bf16 v[40:43], a[216:219], v[192:195], v[40:43]
v_mfma_f32_16x16x32_bf16 v[44:47], a[220:223], v[192:195], v[44:47]
s_waitcnt vmcnt(10)
v_mfma_f32_16x16x32_bf16 v[48:51], a[208:211], v[196:199], v[48:51]
v_mfma_f32_16x16x32_bf16 v[52:55], a[212:215], v[196:199], v[52:55]
s_lshl_b32 s3, s25, 2
s_add_u32 s3, s3, s20
s_mul_i32 s3, s3, 49152
s_lshl_b32 s4, s26, 11
s_add_u32 s3, s3, s4
s_add_u32 s3, s3, s27
s_add_u32 s7, s3, 7864320
v_mfma_f32_16x16x32_bf16 v[56:59], a[216:219], v[196:199], v[56:59]
v_mfma_f32_16x16x32_bf16 v[60:63], a[220:223], v[196:199], v[60:63]
s_waitcnt vmcnt(9)
v_mfma_f32_16x16x32_bf16 v[64:67], a[208:211], v[200:203], v[64:67]
v_mfma_f32_16x16x32_bf16 v[68:71], a[212:215], v[200:203], v[68:71]
s_mul_i32 s3, s25, 24
s_add_u32 s3, s3, s26
s_lshl_b32 s3, s3, 7
s_add_u32 s3, s3, s27
s_add_u32 s6, s3, 12533760
v_mfma_f32_16x16x32_bf16 v[72:75], a[216:219], v[200:203], v[72:75]
v_mfma_f32_16x16x32_bf16 v[76:79], a[220:223], v[200:203], v[76:79]
s_waitcnt vmcnt(8)
v_mfma_f32_16x16x32_bf16 v[80:83], a[208:211], v[204:207], v[80:83]
v_mfma_f32_16x16x32_bf16 v[84:87], a[212:215], v[204:207], v[84:87]
v_mfma_f32_16x16x32_bf16 v[88:91], a[216:219], v[204:207], v[88:91]
v_mfma_f32_16x16x32_bf16 v[92:95], a[220:223], v[204:207], v[92:95]
s_waitcnt vmcnt(7)
v_mfma_f32_16x16x32_bf16 v[32:35], a[224:227], v[96:99], v[32:35]
v_mfma_f32_16x16x32_bf16 v[36:39], a[228:231], v[96:99], v[36:39]
v_mfma_f32_16x16x32_bf16 v[40:43], a[232:235], v[96:99], v[40:43]
v_mfma_f32_16x16x32_bf16 v[44:47], a[236:239], v[96:99], v[44:47]
s_waitcnt vmcnt(6)
v_mfma_f32_16x16x32_bf16 v[48:51], a[224:227], v[100:103], v[48:51]
v_mfma_f32_16x16x32_bf16 v[52:55], a[228:231], v[100:103], v[52:55]
v_mfma_f32_16x16x32_bf16 v[56:59], a[232:235], v[100:103], v[56:59]
v_mfma_f32_16x16x32_bf16 v[60:63], a[236:239], v[100:103], v[60:63]
s_waitcnt vmcnt(5)
v_mfma_f32_16x16x32_bf16 v[64:67], a[224:227], v[104:107], v[64:67]
v_mfma_f32_16x16x32_bf16 v[68:71], a[228:231], v[104:107], v[68:71]
v_mfma_f32_16x16x32_bf16 v[72:75], a[232:235], v[104:107], v[72:75]
v_mfma_f32_16x16x32_bf16 v[76:79], a[236:239], v[104:107], v[76:79]
s_waitcnt vmcnt(4)
v_mfma_f32_16x16x32_bf16 v[80:83], a[224:227], v[108:111], v[80:83]
v_mfma_f32_16x16x32_bf16 v[84:87], a[228:231], v[108:111], v[84:87]
v_mfma_f32_16x16x32_bf16 v[88:91], a[232:235], v[108:111], v[88:91]
v_mfma_f32_16x16x32_bf16 v[92:95], a[236:239], v[108:111], v[92:95]
s_waitcnt vmcnt(3)
v_mfma_f32_16x16x32_bf16 v[32:35], a[240:243], v[112:115], v[32:35]
v_mfma_f32_16x16x32_bf16 v[36:39], a[244:247], v[112:115], v[36:39]
v_mfma_f32_16x16x32_bf16 v[40:43], a[248:251], v[112:115], v[40:43]
v_mfma_f32_16x16x32_bf16 v[44:47], a[252:255], v[112:115], v[44:47]
s_waitcnt vmcnt(2)
v_mfma_f32_16x16x32_bf16 v[48:51], a[240:243], v[116:119], v[48:51]
v_mfma_f32_16x16x32_bf16 v[52:55], a[244:247], v[116:119], v[52:55]
v_mfma_f32_16x16x32_bf16 v[56:59], a[248:251], v[116:119], v[56:59]
v_mfma_f32_16x16x32_bf16 v[60:63], a[252:255], v[116:119], v[60:63]
s_waitcnt vmcnt(1)
v_mfma_f32_16x16x32_bf16 v[64:67], a[240:243], v[120:123], v[64:67]
v_mfma_f32_16x16x32_bf16 v[68:71], a[244:247], v[120:123], v[68:71]
v_mfma_f32_16x16x32_bf16 v[72:75], a[248:251], v[120:123], v[72:75]
v_mfma_f32_16x16x32_bf16 v[76:79], a[252:255], v[120:123], v[76:79]
s_waitcnt vmcnt(0)
v_mfma_f32_16x16x32_bf16 v[80:83], a[240:243], v[124:127], v[80:83]
v_mfma_f32_16x16x32_bf16 v[84:87], a[244:247], v[124:127], v[84:87]
v_mfma_f32_16x16x32_bf16 v[88:91], a[248:251], v[124:127], v[88:91]
v_mfma_f32_16x16x32_bf16 v[92:95], a[252:255], v[124:127], v[92:95]
ds_write_b128 v8, v[48:51] offset:0
ds_write_b128 v8, v[52:55] offset:1024
ds_write_b128 v8, v[56:59] offset:2048
ds_write_b128 v8, v[60:63] offset:3072
ds_write_b128 v9, v[64:67] offset:0
ds_write_b128 v9, v[68:71] offset:1024
ds_write_b128 v9, v[72:75] offset:2048
ds_write_b128 v9, v[76:79] offset:3072
ds_write_b128 v10, v[80:83] offset:0
ds_write_b128 v10, v[84:87] offset:1024
ds_write_b128 v10, v[88:91] offset:2048
ds_write_b128 v10, v[92:95] offset:3072
s_waitcnt lgkmcnt(0)
s_barrier
ds_read_b128 v[96:99], v11 offset:0
ds_read_b128 v[100:103], v11 offset:1024
ds_read_b128 v[104:107], v11 offset:2048
ds_read_b128 v[108:111], v11 offset:3072
ds_read_b128 v[112:115], v11 offset:5120
ds_read_b128 v[116:119], v11 offset:6144
ds_read_b128 v[120:123], v11 offset:7168
ds_read_b128 v[124:127], v11 offset:8192
ds_read_b128 v[128:131], v11 offset:10240
ds_read_b128 v[132:135], v11 offset:11264
ds_read_b128 v[136:139], v11 offset:12288
ds_read_b128 v[140:143], v11 offset:13312
s_waitcnt lgkmcnt(8)
v_pk_add_f32 v[144:145], v[32:33], v[96:97]
v_pk_add_f32 v[146:147], v[34:35], v[98:99]
v_pk_add_f32 v[148:149], v[36:37], v[100:101]
v_pk_add_f32 v[150:151], v[38:39], v[102:103]
v_pk_add_f32 v[152:153], v[40:41], v[104:105]
v_pk_add_f32 v[154:155], v[42:43], v[106:107]
v_pk_add_f32 v[156:157], v[44:45], v[108:109]
v_pk_add_f32 v[158:159], v[46:47], v[110:111]
s_waitcnt lgkmcnt(4)
v_pk_add_f32 v[144:145], v[144:145], v[112:113]
v_pk_add_f32 v[146:147], v[146:147], v[114:115]
v_pk_add_f32 v[148:149], v[148:149], v[116:117]
v_pk_add_f32 v[150:151], v[150:151], v[118:119]
v_pk_add_f32 v[152:153], v[152:153], v[120:121]
v_pk_add_f32 v[154:155], v[154:155], v[122:123]
v_pk_add_f32 v[156:157], v[156:157], v[124:125]
v_pk_add_f32 v[158:159], v[158:159], v[126:127]
s_waitcnt lgkmcnt(0)
v_pk_add_f32 v[144:145], v[144:145], v[128:129]
v_pk_add_f32 v[146:147], v[146:147], v[130:131]
v_pk_add_f32 v[148:149], v[148:149], v[132:133]
v_pk_add_f32 v[150:151], v[150:151], v[134:135]
v_pk_add_f32 v[152:153], v[152:153], v[136:137]
v_pk_add_f32 v[154:155], v[154:155], v[138:139]
v_pk_add_f32 v[156:157], v[156:157], v[140:141]
v_pk_add_f32 v[158:159], v[158:159], v[142:143]
v_lshlrev_b32 v96, 16, v12
v_and_b32 v97, s37, v12
v_lshlrev_b32 v98, 16, v13
v_and_b32 v99, s37, v13
v_lshlrev_b32 v100, 16, v14
v_and_b32 v101, s37, v14
v_lshlrev_b32 v102, 16, v15
v_and_b32 v103, s37, v15
v_lshlrev_b32 v104, 16, v16
v_and_b32 v105, s37, v16
v_lshlrev_b32 v106, 16, v17
v_and_b32 v107, s37, v17
v_lshlrev_b32 v108, 16, v18
v_and_b32 v109, s37, v18
v_lshlrev_b32 v110, 16, v19
v_and_b32 v111, s37, v19
v_pk_add_f32 v[144:145], v[144:145], v[96:97]
v_pk_add_f32 v[146:147], v[146:147], v[98:99]
v_pk_add_f32 v[148:149], v[148:149], v[100:101]
v_pk_add_f32 v[150:151], v[150:151], v[102:103]
v_pk_add_f32 v[152:153], v[152:153], v[104:105]
v_pk_add_f32 v[154:155], v[154:155], v[106:107]
v_pk_add_f32 v[156:157], v[156:157], v[108:109]
v_pk_add_f32 v[158:159], v[158:159], v[110:111]
v_pk_mul_f32 v[96:97], v[144:145], v[144:145]
v_pk_mul_f32 v[98:99], v[146:147], v[146:147]
v_pk_mul_f32 v[100:101], v[148:149], v[148:149]
v_pk_mul_f32 v[102:103], v[150:151], v[150:151]
v_pk_mul_f32 v[104:105], v[152:153], v[152:153]
v_pk_mul_f32 v[106:107], v[154:155], v[154:155]
v_pk_mul_f32 v[108:109], v[156:157], v[156:157]
v_pk_mul_f32 v[110:111], v[158:159], v[158:159]
v_fma_f32 v96, v96, s36, v28
v_fma_f32 v97, v97, s36, v28
v_fma_f32 v98, v98, s36, v28
v_fma_f32 v99, v99, s36, v28
v_fma_f32 v100, v100, s36, v28
v_fma_f32 v101, v101, s36, v28
v_fma_f32 v102, v102, s36, v28
v_fma_f32 v103, v103, s36, v28
v_fma_f32 v104, v104, s36, v28
v_fma_f32 v105, v105, s36, v28
v_fma_f32 v106, v106, s36, v28
v_fma_f32 v107, v107, s36, v28
v_fma_f32 v108, v108, s36, v28
v_fma_f32 v109, v109, s36, v28
v_fma_f32 v110, v110, s36, v28
v_fma_f32 v111, v111, s36, v28
v_pk_mul_f32 v[96:97], v[96:97], v[144:145]
v_pk_mul_f32 v[98:99], v[98:99], v[146:147]
v_pk_mul_f32 v[100:101], v[100:101], v[148:149]
v_pk_mul_f32 v[102:103], v[102:103], v[150:151]
v_pk_mul_f32 v[104:105], v[104:105], v[152:153]
v_pk_mul_f32 v[106:107], v[106:107], v[154:155]
v_pk_mul_f32 v[108:109], v[108:109], v[156:157]
v_pk_mul_f32 v[110:111], v[110:111], v[158:159]
v_exp_f32 v96, v96
v_exp_f32 v97, v97
v_exp_f32 v98, v98
v_exp_f32 v99, v99
v_exp_f32 v100, v100
v_exp_f32 v101, v101
v_exp_f32 v102, v102
v_exp_f32 v103, v103
v_exp_f32 v104, v104
v_exp_f32 v105, v105
v_exp_f32 v106, v106
v_exp_f32 v107, v107
v_exp_f32 v108, v108
v_exp_f32 v109, v109
v_exp_f32 v110, v110
v_exp_f32 v111, v111
v_add_f32 v96, 1.0, v96
v_add_f32 v97, 1.0, v97
v_add_f32 v98, 1.0, v98
v_add_f32 v99, 1.0, v99
v_add_f32 v100, 1.0, v100
v_add_f32 v101, 1.0, v101
v_add_f32 v102, 1.0, v102
v_add_f32 v103, 1.0, v103
v_add_f32 v104, 1.0, v104
v_add_f32 v105, 1.0, v105
v_add_f32 v106, 1.0, v106
v_add_f32 v107, 1.0, v107
v_add_f32 v108, 1.0, v108
v_add_f32 v109, 1.0, v109
v_add_f32 v110, 1.0, v110
v_add_f32 v111, 1.0, v111
v_rcp_f32 v96, v96
v_rcp_f32 v97, v97
v_rcp_f32 v98, v98
v_rcp_f32 v99, v99
v_rcp_f32 v100, v100
v_rcp_f32 v101, v101
v_rcp_f32 v102, v102
v_rcp_f32 v103, v103
v_rcp_f32 v104, v104
v_rcp_f32 v105, v105
v_rcp_f32 v106, v106
v_rcp_f32 v107, v107
v_rcp_f32 v108, v108
v_rcp_f32 v109, v109
v_rcp_f32 v110, v110
v_rcp_f32 v111, v111
v_pk_mul_f32 v[96:97], v[96:97], v[144:145]
v_pk_mul_f32 v[98:99], v[98:99], v[146:147]
v_pk_mul_f32 v[100:101], v[100:101], v[148:149]
v_pk_mul_f32 v[102:103], v[102:103], v[150:151]
v_pk_mul_f32 v[104:105], v[104:105], v[152:153]
v_pk_mul_f32 v[106:107], v[106:107], v[154:155]
v_pk_mul_f32 v[108:109], v[108:109], v[156:157]
v_pk_mul_f32 v[110:111], v[110:111], v[158:159]
v_cvt_pk_bf16_f32 v144, v96, v97
v_cvt_pk_bf16_f32 v145, v98, v99
v_cvt_pk_bf16_f32 v146, v100, v101
v_cvt_pk_bf16_f32 v147, v102, v103
v_cvt_pk_bf16_f32 v148, v104, v105
v_cvt_pk_bf16_f32 v149, v106, v107
v_cvt_pk_bf16_f32 v150, v108, v109
v_cvt_pk_bf16_f32 v151, v110, v111
buffer_store_dwordx4 v[144:147], v2, s[8:11], s7 offen sc1
buffer_store_dwordx4 v[148:151], v2, s[8:11], s7 offen offset:1024 sc1
s_add_u32 m0, s50, 0
s_add_u32 s53, s49, 786432
buffer_load_dwordx4 v224, s[64:67], s53 offen offset:0 lds
buffer_load_dwordx4 v225, s[64:67], s53 offen offset:1024 lds
buffer_load_dwordx4 v226, s[64:67], s53 offen offset:2048 lds
buffer_load_dwordx4 v227, s[64:67], s53 offen offset:3072 lds
s_add_u32 m0, s50, 4096
s_add_u32 s53, s49, 917504
buffer_load_dwordx4 v224, s[64:67], s53 offen offset:0 lds
buffer_load_dwordx4 v225, s[64:67], s53 offen offset:1024 lds
buffer_load_dwordx4 v226, s[64:67], s53 offen offset:2048 lds
buffer_load_dwordx4 v227, s[64:67], s53 offen offset:3072 lds
s_waitcnt vmcnt(8)
s_barrier
s_cmp_lg_u32 s20, 0
s_cbranch_scc1 mn_nf16
s_mov_b64 exec, 1
v_mov_b32 v30, s69
buffer_store_dword v30, v255, s[8:11], s6 offen sc1
s_mov_b64 exec, -1
mn_nf16:
s_add_u32 m0, s50, 8192
s_add_u32 s53, s49, 1048576
buffer_load_dwordx4 v224, s[64:67], s53 offen offset:0 lds
buffer_load_dwordx4 v225, s[64:67], s53 offen offset:1024 lds
buffer_load_dwordx4 v226, s[64:67], s53 offen offset:2048 lds
buffer_load_dwordx4 v227, s[64:67], s53 offen offset:3072 lds
s_add_u32 m0, s50, 12288
s_add_u32 s53, s49, 1179648
buffer_load_dwordx4 v224, s[64:67], s53 offen offset:0 lds
buffer_load_dwordx4 v225, s[64:67], s53 offen offset:1024 lds
buffer_load_dwordx4 v226, s[64:67], s53 offen offset:2048 lds
buffer_load_dwordx4 v227, s[64:67], s53 offen offset:3072 lds
s_add_u32 m0, s50, 16384
s_add_u32 s53, s49, 1310720
buffer_load_dwordx4 v224, s[64:67], s53 offen offset:0 lds
buffer_load_dwordx4 v225, s[64:67], s53 offen offset:1024 lds
buffer_load_dwordx4 v226, s[64:67], s53 offen offset:2048 lds
buffer_load_dwordx4 v227, s[64:67], s53 offen offset:3072 lds
s_mov_b32 m0, s51
s_add_u32 s53, s49, 1441792
buffer_load_dwordx4 v224, s[64:67], s53 offen offset:0 lds
buffer_load_dwordx4 v225, s[64:67], s53 offen offset:1024 lds
buffer_load_dwordx4 v226, s[64:67], s53 offen offset:2048 lds
buffer_load_dwordx4 v227, s[64:67], s53 offen offset:3072 lds
s_branch mn_b2
mn_b1skip:
s_waitcnt vmcnt(0)
ds_read_b64_tr_b16 a[0:1], v216 offset:0
ds_read_b64_tr_b16 a[2:3], v216 offset:2048
ds_read_b64_tr_b16 a[4:5], v217 offset:0
ds_read_b64_tr_b16 a[6:7], v217 offset:2048
ds_read_b64_tr_b16 a[8:9], v218 offset:0
ds_read_b64_tr_b16 a[10:11], v218 offset:2048
ds_read_b64_tr_b16 a[12:13], v219 offset:0
ds_read_b64_tr_b16 a[14:15], v219 offset:2048
s_waitcnt lgkmcnt(8)
ds_read_b64_tr_b16 a[16:17], v216 offset:4096
ds_read_b64_tr_b16 a[18:19], v216 offset:6144
ds_read_b64_tr_b16 a[20:21], v217 offset:4096
ds_read_b64_tr_b16 a[22:23], v217 offset:6144
ds_read_b64_tr_b16 a[24:25], v218 offset:4096
ds_read_b64_tr_b16 a[26:27], v218 offset:6144
ds_read_b64_tr_b16 a[28:29], v219 offset:4096
ds_read_b64_tr_b16 a[30:31], v219 offset:6144
s_waitcnt lgkmcnt(8)
ds_read_b64_tr_b16 a[32:33], v216 offset:8192
ds_read_b64_tr_b16 a[34:35], v216 offset:10240
ds_read_b64_tr_b16 a[36:37], v217 offset:8192
ds_read_b64_tr_b16 a[38:39], v217 offset:10240
ds_read_b64_tr_b16 a[40:41], v218 offset:8192
ds_read_b64_tr_b16 a[42:43], v218 offset:10240
ds_read_b64_tr_b16 a[44:45], v219 offset:8192
ds_read_b64_tr_b16 a[46:47], v219 offset:10240
s_waitcnt lgkmcnt(8)
ds_read_b64_tr_b16 a[48:49], v216 offset:12288
ds_read_b64_tr_b16 a[50:51], v216 offset:14336
ds_read_b64_tr_b16 a[52:53], v217 offset:12288
ds_read_b64_tr_b16 a[54:55], v217 offset:14336
ds_read_b64_tr_b16 a[56:57], v218 offset:12288
ds_read_b64_tr_b16 a[58:59], v218 offset:14336
ds_read_b64_tr_b16 a[60:61], v219 offset:12288
ds_read_b64_tr_b16 a[62:63], v219 offset:14336
s_waitcnt lgkmcnt(8)
ds_read_b64_tr_b16 a[64:65], v216 offset:16384
ds_read_b64_tr_b16 a[66:67], v216 offset:18432
ds_read_b64_tr_b16 a[68:69], v217 offset:16384
ds_read_b64_tr_b16 a[70:71], v217 offset:18432
ds_read_b64_tr_b16 a[72:73], v218 offset:16384
ds_read_b64_tr_b16 a[74:75], v218 offset:18432
ds_read_b64_tr_b16 a[76:77], v219 offset:16384
ds_read_b64_tr_b16 a[78:79], v219 offset:18432
s_waitcnt lgkmcnt(8)
ds_read_b64_tr_b16 a[80:81], v220 offset:0
ds_read_b64_tr_b16 a[82:83], v220 offset:2048
ds_read_b64_tr_b16 a[84:85], v221 offset:0
ds_read_b64_tr_b16 a[86:87], v221 offset:2048
ds_read_b64_tr_b16 a[88:89], v222 offset:0
ds_read_b64_tr_b16 a[90:91], v222 offset:2048
ds_read_b64_tr_b16 a[92:93], v223 offset:0
ds_read_b64_tr_b16 a[94:95], v223 offset:2048
s_waitcnt lgkmcnt(8)
s_waitcnt lgkmcnt(0)
s_add_u32 m0, s50, 0
s_add_u32 s53, s49, 786432
buffer_load_dwordx4 v224, s[64:67], s53 offen offset:0 lds
buffer_load_dwordx4 v225, s[64:67], s53 offen offset:1024 lds
buffer_load_dwordx4 v226, s[64:67], s53 offen offset:2048 lds
buffer_load_dwordx4 v227, s[64:67], s53 offen offset:3072 lds
s_add_u32 m0, s50, 4096
s_add_u32 s53, s49, 917504
buffer_load_dwordx4 v224, s[64:67], s53 offen offset:0 lds
buffer_load_dwordx4 v225, s[64:67], s53 offen offset:1024 lds
buffer_load_dwordx4 v226, s[64:67], s53 offen offset:2048 lds
buffer_load_dwordx4 v227, s[64:67], s53 offen offset:3072 lds
s_add_u32 m0, s50, 8192
s_add_u32 s53, s49, 1048576
buffer_load_dwordx4 v224, s[64:67], s53 offen offset:0 lds
buffer_load_dwordx4 v225, s[64:67], s53 offen offset:1024 lds
buffer_load_dwordx4 v226, s[64:67], s53 offen offset:2048 lds
buffer_load_dwordx4 v227, s[64:67], s53 offen offset:3072 lds
s_add_u32 m0, s50, 12288
s_add_u32 s53, s49, 1179648
buffer_load_dwordx4 v224, s[64:67], s53 offen offset:0 lds
buffer_load_dwordx4 v225, s[64:67], s53 offen offset:1024 lds
buffer_load_dwordx4 v226, s[64:67], s53 offen offset:2048 lds
buffer_load_dwordx4 v227, s[64:67], s53 offen offset:3072 lds
s_add_u32 m0, s50, 16384
s_add_u32 s53, s49, 1310720
buffer_load_dwordx4 v224, s[64:67], s53 offen offset:0 lds
buffer_load_dwordx4 v225, s[64:67], s53 offen offset:1024 lds
buffer_load_dwordx4 v226, s[64:67], s53 offen offset:2048 lds
buffer_load_dwordx4 v227, s[64:67], s53 offen offset:3072 lds
s_mov_b32 m0, s51
s_add_u32 s53, s49, 1441792
buffer_load_dwordx4 v224, s[64:67], s53 offen offset:0 lds
buffer_load_dwordx4 v225, s[64:67], s53 offen offset:1024 lds
buffer_load_dwordx4 v226, s[64:67], s53 offen offset:2048 lds
buffer_load_dwordx4 v227, s[64:67], s53 offen offset:3072 lds
s_bfe_u32 s3, s2, 0x10003
s_lshl_b32 s3, s3, 2
s_add_u32 s3, s3, s20
s_and_b32 s4, s23, 24
s_add_u32 s3, s3, s4
s_lshl_b32 s3, s3, 7
s_add_u32 s3, s3, 786432
v_lshlrev_b32 v26, 12, v1
s_add_u32 s4, s3, 0
buffer_load_dword v27, v26, s[64:67], s4 offen
s_add_u32 s4, s3, 262144
buffer_load_dword v27, v26, s[64:67], s4 offen
s_add_u32 s4, s3, 524288
buffer_load_dword v27, v26, s[64:67], s4 offen
s_add_u32 s4, s3, 1572864
buffer_load_dword v27, v26, s[64:67], s4 offen
s_add_u32 s4, s3, 1835008
buffer_load_dword v27, v26, s[64:67], s4 offen
s_add_u32 s4, s3, 2097152
buffer_load_dword v27, v26, s[64:67], s4 offen
s_add_u32 s4, s3, 3145728
buffer_load_dword v27, v26, s[64:67], s4 offen
s_add_u32 s4, s3, 3407872
buffer_load_dword v27, v26, s[64:67], s4 offen
s_add_u32 s4, s3, 3670016
buffer_load_dword v27, v26, s[64:67], s4 offen
s_add_u32 s4, s3, 4718592
buffer_load_dword v27, v26, s[64:67], s4 offen
s_add_u32 s4, s3, 4980736
buffer_load_dword v27, v26, s[64:67], s4 offen
s_add_u32 s4, s3, 5242880
buffer_load_dword v27, v26, s[64:67], s4 offen
mn_b2:
v_cmp_le_u32 vcc, 6, v1
s_nop 1
v_cndmask_b32 v28, 0, 18, vcc
v_add_u32 v28, v28, v1
v_lshlrev_b32 v28, 7, v28
s_mul_i32 s3, s24, 80
s_lshr_b32 s3, s3, 6
s_mul_i32 s3, s3, 24
s_mul_i32 s4, s20, 6
s_add_u32 s3, s3, s4
s_lshl_b32 s3, s3, 7
s_add_u32 s3, s3, s27
s_add_u32 s6, s3, 12533760
s_mul_i32 s3, s24, 245760
s_mul_i32 s4, s20, 12288
s_add_u32 s3, s3, s4
s_add_u32 s3, s3, s27
s_add_u32 s30, s3, 7864320
s_add_u32 s31, s30, 49152
s_add_u32 s32, s30, 98304
s_add_u32 s33, s30, 147456
s_add_u32 s36, s30, 196608
v_lshlrev_b32 v12, 1, v4
s_lshl_b32 s3, s23, 7
s_lshl_b32 s4, s20, 5
s_add_u32 s35, s3, s4
buffer_load_ushort v12, v12, s[16:19], s35 offen
v_mfma_f32_16x16x32_bf16 v[32:35], v[244:247], v[236:239], 0
v_mfma_f32_16x16x32_bf16 v[36:39], v[246:249], v[236:239], 0
v_mfma_f32_16x16x32_bf16 v[40:43], v[248:251], v[236:239], 0
v_mfma_f32_16x16x32_bf16 v[44:47], v[250:253], v[236:239], 0
v_mfma_f32_16x16x32_bf16 v[48:51], v[252:255], v[236:239], 0
s_add_u32 s3, s20, 1
s_and_b32 s3, s3, 3
s_mul_i32 s3, s3, 15360
s_add_u32 s3, s3, 102400
v_add_u32 v8, s3, v2
s_add_u32 s3, s20, 2
s_and_b32 s3, s3, 3
s_mul_i32 s3, s3, 15360
s_add_u32 s3, s3, 107520
v_add_u32 v9, s3, v2
s_add_u32 s3, s20, 3
s_and_b32 s3, s3, 3
s_mul_i32 s3, s3, 15360
s_add_u32 s3, s3, 112640
v_add_u32 v10, s3, v2
s_add_u32 s3, s20, 0
s_and_b32 s3, s3, 3
s_mul_i32 s3, s3, 15360
s_add_u32 s3, s3, 102400
v_add_u32 v11, s3, v2
s_lshl_b32 s3, s28, 30
v_add_u32 v13, s3, v2
s_mov_b64 exec, 0xfff
s_mov_b32 s5, 262144
mn_poll17:
buffer_load_dword v29, v28, s[8:11], s6 offen sc1
s_sub_u32 s5, s5, 1
s_cbranch_scc1 mn_pout18
s_waitcnt vmcnt(0)
v_cmpx_ne_u32 vcc, s69, v29
s_cbranch_execnz mn_poll17
mn_pout18:
s_waitcnt vmcnt(0)
s_mov_b64 exec, -1
s_nop 3
s_mov_b32 s37, s30
s_mov_b32 s38, s31
buffer_load_dwordx4 v[112:115], v2, s[8:11], s37 offen offset:0 sc1
ds_read_b64_tr_b16 a[96:97], v216 offset:0
ds_read_b64_tr_b16 a[98:99], v216 offset:2048
buffer_load_dwordx4 v[116:119], v2, s[8:11], s38 offen offset:0 sc1
ds_read_b64_tr_b16 a[100:101], v217 offset:0
ds_read_b64_tr_b16 a[102:103], v217 offset:2048
buffer_load_dwordx4 v[120:123], v2, s[8:11], s32 offen offset:0 sc1
ds_read_b64_tr_b16 a[104:105], v218 offset:0
ds_read_b64_tr_b16 a[106:107], v218 offset:2048
buffer_load_dwordx4 v[124:127], v2, s[8:11], s33 offen offset:0 sc1
ds_read_b64_tr_b16 a[108:109], v219 offset:0
ds_read_b64_tr_b16 a[110:111], v219 offset:2048
s_waitcnt lgkmcnt(8)
buffer_load_dwordx4 v[128:131], v2, s[8:11], s36 offen offset:0 sc1
ds_read_b64_tr_b16 a[112:113], v216 offset:4096
ds_read_b64_tr_b16 a[114:115], v216 offset:6144
buffer_load_dwordx4 v[132:135], v2, s[8:11], s37 offen offset:1024 sc1
ds_read_b64_tr_b16 a[116:117], v217 offset:4096
ds_read_b64_tr_b16 a[118:119], v217 offset:6144
buffer_load_dwordx4 v[136:139], v2, s[8:11], s38 offen offset:1024 sc1
ds_read_b64_tr_b16 a[120:121], v218 offset:4096
ds_read_b64_tr_b16 a[122:123], v218 offset:6144
buffer_load_dwordx4 v[140:143], v2, s[8:11], s32 offen offset:1024 sc1
ds_read_b64_tr_b16 a[124:125], v219 offset:4096
ds_read_b64_tr_b16 a[126:127], v219 offset:6144
s_waitcnt lgkmcnt(8)
buffer_load_dwordx4 v[144:147], v2, s[8:11], s33 offen offset:1024 sc1
ds_read_b64_tr_b16 a[128:129], v216 offset:8192
ds_read_b64_tr_b16 a[130:131], v216 offset:10240
buffer_load_dwordx4 v[148:151], v2, s[8:11], s36 offen offset:1024 sc1
ds_read_b64_tr_b16 a[132:133], v217 offset:8192
ds_read_b64_tr_b16 a[134:135], v217 offset:10240
buffer_load_dwordx4 v[152:155], v2, s[8:11], s37 offen offset:2048 sc1
ds_read_b64_tr_b16 a[136:137], v218 offset:8192
ds_read_b64_tr_b16 a[138:139], v218 offset:10240
buffer_load_dwordx4 v[156:159], v2, s[8:11], s38 offen offset:2048 sc1
ds_read_b64_tr_b16 a[140:141], v219 offset:8192
ds_read_b64_tr_b16 a[142:143], v219 offset:10240
s_waitcnt lgkmcnt(8)
v_lshlrev_b32 v12, 16, v12
s_waitcnt vmcnt(11)
v_mfma_f32_16x16x32_bf16 v[32:35], v[112:115], a[0:3], v[32:35]
buffer_load_dwordx4 v[160:163], v2, s[8:11], s32 offen offset:2048 sc1
v_mfma_f32_16x16x32_bf16 v[52:55], v[112:115], a[4:7], 0
ds_read_b64_tr_b16 a[144:145], v216 offset:12288
v_mfma_f32_16x16x32_bf16 v[72:75], v[112:115], a[8:11], 0
buffer_load_dwordx4 v[164:167], v2, s[8:11], s33 offen offset:2048 sc1
v_mfma_f32_16x16x32_bf16 v[92:95], v[112:115], a[12:15], 0
ds_read_b64_tr_b16 a[146:147], v216 offset:14336
s_waitcnt vmcnt(12)
v_mfma_f32_16x16x32_bf16 v[36:39], v[116:119], a[0:3], v[36:39]
buffer_load_dwordx4 v[168:171], v2, s[8:11], s36 offen offset:2048 sc1
v_mfma_f32_16x16x32_bf16 v[56:59], v[116:119], a[4:7], 0
ds_read_b64_tr_b16 a[148:149], v217 offset:12288
v_mfma_f32_16x16x32_bf16 v[76:79], v[116:119], a[8:11], 0
buffer_load_dwordx4 v[172:175], v2, s[8:11], s37 offen offset:3072 sc1
v_mfma_f32_16x16x32_bf16 v[96:99], v[116:119], a[12:15], 0
ds_read_b64_tr_b16 a[150:151], v217 offset:14336
s_waitcnt vmcnt(13)
v_mfma_f32_16x16x32_bf16 v[40:43], v[120:123], a[0:3], v[40:43]
buffer_load_dwordx4 v[176:179], v2, s[8:11], s38 offen offset:3072 sc1
v_mfma_f32_16x16x32_bf16 v[60:63], v[120:123], a[4:7], 0
ds_read_b64_tr_b16 a[152:153], v218 offset:12288
v_mfma_f32_16x16x32_bf16 v[80:83], v[120:123], a[8:11], 0
buffer_load_dwordx4 v[180:183], v2, s[8:11], s32 offen offset:3072 sc1
v_mfma_f32_16x16x32_bf16 v[100:103], v[120:123], a[12:15], 0
ds_read_b64_tr_b16 a[154:155], v218 offset:14336
s_waitcnt vmcnt(14)
v_mfma_f32_16x16x32_bf16 v[44:47], v[124:127], a[0:3], v[44:47]
buffer_load_dwordx4 v[184:187], v2, s[8:11], s33 offen offset:3072 sc1
v_mfma_f32_16x16x32_bf16 v[64:67], v[124:127], a[4:7], 0
ds_read_b64_tr_b16 a[156:157], v219 offset:12288
v_mfma_f32_16x16x32_bf16 v[84:87], v[124:127], a[8:11], 0
buffer_load_dwordx4 v[188:191], v2, s[8:11], s36 offen offset:3072 sc1
v_mfma_f32_16x16x32_bf16 v[104:107], v[124:127], a[12:15], 0
ds_read_b64_tr_b16 a[158:159], v219 offset:14336
s_waitcnt lgkmcnt(8)
s_waitcnt vmcnt(15)
v_mfma_f32_16x16x32_bf16 v[48:51], v[128:131], a[0:3], v[48:51]
buffer_load_dwordx4 v[192:195], v3, s[8:11], s37 offen offset:0 sc1
v_mfma_f32_16x16x32_bf16 v[68:71], v[128:131], a[4:7], 0
ds_read_b64_tr_b16 a[160:161], v216 offset:16384
v_mfma_f32_16x16x32_bf16 v[88:91], v[128:131], a[8:11], 0
buffer_load_dwordx4 v[196:199], v3, s[8:11], s38 offen offset:0 sc1
v_mfma_f32_16x16x32_bf16 v[108:111], v[128:131], a[12:15], 0
ds_read_b64_tr_b16 a[162:163], v216 offset:18432
s_waitcnt vmcnt(16)
v_mfma_f32_16x16x32_bf16 v[32:35], v[132:135], a[16:19], v[32:35]
buffer_load_dwordx4 v[200:203], v3, s[8:11], s32 offen offset:0 sc1
v_mfma_f32_16x16x32_bf16 v[52:55], v[132:135], a[20:23], v[52:55]
ds_read_b64_tr_b16 a[164:165], v217 offset:16384
v_mfma_f32_16x16x32_bf16 v[72:75], v[132:135], a[24:27], v[72:75]
buffer_load_dwordx4 v[204:207], v3, s[8:11], s33 offen offset:0 sc1
v_mfma_f32_16x16x32_bf16 v[92:95], v[132:135], a[28:31], v[92:95]
ds_read_b64_tr_b16 a[166:167], v217 offset:18432
s_waitcnt vmcnt(17)
v_mfma_f32_16x16x32_bf16 v[36:39], v[136:139], a[16:19], v[36:39]
buffer_load_dwordx4 v[112:115], v3, s[8:11], s36 offen offset:0 sc1
v_mfma_f32_16x16x32_bf16 v[56:59], v[136:139], a[20:23], v[56:59]
ds_read_b64_tr_b16 a[168:169], v218 offset:16384
v_mfma_f32_16x16x32_bf16 v[76:79], v[136:139], a[24:27], v[76:79]
buffer_load_dwordx4 v[116:119], v3, s[8:11], s37 offen offset:1024 sc1
v_mfma_f32_16x16x32_bf16 v[96:99], v[136:139], a[28:31], v[96:99]
ds_read_b64_tr_b16 a[170:171], v218 offset:18432
s_waitcnt vmcnt(18)
v_mfma_f32_16x16x32_bf16 v[40:43], v[140:143], a[16:19], v[40:43]
buffer_load_dwordx4 v[120:123], v3, s[8:11], s38 offen offset:1024 sc1
v_mfma_f32_16x16x32_bf16 v[60:63], v[140:143], a[20:23], v[60:63]
ds_read_b64_tr_b16 a[172:173], v219 offset:16384
v_mfma_f32_16x16x32_bf16 v[80:83], v[140:143], a[24:27], v[80:83]
buffer_load_dwordx4 v[124:127], v3, s[8:11], s32 offen offset:1024 sc1
v_mfma_f32_16x16x32_bf16 v[100:103], v[140:143], a[28:31], v[100:103]
ds_read_b64_tr_b16 a[174:175], v219 offset:18432
s_waitcnt lgkmcnt(8)
s_waitcnt vmcnt(19)
v_mfma_f32_16x16x32_bf16 v[44:47], v[144:147], a[16:19], v[44:47]
buffer_load_dwordx4 v[128:131], v3, s[8:11], s33 offen offset:1024 sc1
v_mfma_f32_16x16x32_bf16 v[64:67], v[144:147], a[20:23], v[64:67]
ds_read_b64_tr_b16 a[176:177], v220 offset:0
v_mfma_f32_16x16x32_bf16 v[84:87], v[144:147], a[24:27], v[84:87]
buffer_load_dwordx4 v[132:135], v3, s[8:11], s36 offen offset:1024 sc1
v_mfma_f32_16x16x32_bf16 v[104:107], v[144:147], a[28:31], v[104:107]
ds_read_b64_tr_b16 a[178:179], v220 offset:2048
s_waitcnt vmcnt(20)
v_mfma_f32_16x16x32_bf16 v[48:51], v[148:151], a[16:19], v[48:51]
buffer_load_dwordx4 v[136:139], v3, s[8:11], s37 offen offset:2048 sc1
v_mfma_f32_16x16x32_bf16 v[68:71], v[148:151], a[20:23], v[68:71]
ds_read_b64_tr_b16 a[180:181], v221 offset:0
v_mfma_f32_16x16x32_bf16 v[88:91], v[148:151], a[24:27], v[88:91]
buffer_load_dwordx4 v[140:143], v3, s[8:11], s38 offen offset:2048 sc1
v_mfma_f32_16x16x32_bf16 v[108:111], v[148:151], a[28:31], v[108:111]
ds_read_b64_tr_b16 a[182:183], v221 offset:2048
s_waitcnt vmcnt(21)
v_mfma_f32_16x16x32_bf16 v[32:35], v[152:155], a[32:35], v[32:35]
buffer_load_dwordx4 v[144:147], v3, s[8:11], s32 offen offset:2048 sc1
v_mfma_f32_16x16x32_bf16 v[52:55], v[152:155], a[36:39], v[52:55]
ds_read_b64_tr_b16 a[184:185], v222 offset:0
v_mfma_f32_16x16x32_bf16 v[72:75], v[152:155], a[40:43], v[72:75]
buffer_load_dwordx4 v[148:151], v3, s[8:11], s33 offen offset:2048 sc1
v_mfma_f32_16x16x32_bf16 v[92:95], v[152:155], a[44:47], v[92:95]
ds_read_b64_tr_b16 a[186:187], v222 offset:2048
s_waitcnt vmcnt(22)
v_mfma_f32_16x16x32_bf16 v[36:39], v[156:159], a[32:35], v[36:39]
buffer_load_dwordx4 v[152:155], v3, s[8:11], s36 offen offset:2048 sc1
v_mfma_f32_16x16x32_bf16 v[56:59], v[156:159], a[36:39], v[56:59]
ds_read_b64_tr_b16 a[188:189], v223 offset:0
v_mfma_f32_16x16x32_bf16 v[76:79], v[156:159], a[40:43], v[76:79]
v_mfma_f32_16x16x32_bf16 v[96:99], v[156:159], a[44:47], v[96:99]
ds_read_b64_tr_b16 a[190:191], v223 offset:2048
s_waitcnt lgkmcnt(8)
s_waitcnt vmcnt(22)
v_mfma_f32_16x16x32_bf16 v[40:43], v[160:163], a[32:35], v[40:43]
buffer_load_dwordx4 v[156:159], v3, s[8:11], s37 offen offset:3072 sc1
v_mfma_f32_16x16x32_bf16 v[60:63], v[160:163], a[36:39], v[60:63]
v_mfma_f32_16x16x32_bf16 v[80:83], v[160:163], a[40:43], v[80:83]
v_mfma_f32_16x16x32_bf16 v[100:103], v[160:163], a[44:47], v[100:103]
s_waitcnt vmcnt(22)
v_mfma_f32_16x16x32_bf16 v[44:47], v[164:167], a[32:35], v[44:47]
buffer_load_dwordx4 v[160:163], v3, s[8:11], s38 offen offset:3072 sc1
v_mfma_f32_16x16x32_bf16 v[64:67], v[164:167], a[36:39], v[64:67]
v_mfma_f32_16x16x32_bf16 v[84:87], v[164:167], a[40:43], v[84:87]
v_mfma_f32_16x16x32_bf16 v[104:107], v[164:167], a[44:47], v[104:107]
s_waitcnt vmcnt(22)
v_mfma_f32_16x16x32_bf16 v[48:51], v[168:171], a[32:35], v[48:51]
buffer_load_dwordx4 v[164:167], v3, s[8:11], s32 offen offset:3072 sc1
v_mfma_f32_16x16x32_bf16 v[68:71], v[168:171], a[36:39], v[68:71]
v_mfma_f32_16x16x32_bf16 v[88:91], v[168:171], a[40:43], v[88:91]
v_mfma_f32_16x16x32_bf16 v[108:111], v[168:171], a[44:47], v[108:111]
s_waitcnt vmcnt(22)
v_mfma_f32_16x16x32_bf16 v[32:35], v[172:175], a[48:51], v[32:35]
buffer_load_dwordx4 v[168:171], v3, s[8:11], s33 offen offset:3072 sc1
v_mfma_f32_16x16x32_bf16 v[52:55], v[172:175], a[52:55], v[52:55]
v_mfma_f32_16x16x32_bf16 v[72:75], v[172:175], a[56:59], v[72:75]
v_mfma_f32_16x16x32_bf16 v[92:95], v[172:175], a[60:63], v[92:95]
s_waitcnt vmcnt(22)
v_mfma_f32_16x16x32_bf16 v[36:39], v[176:179], a[48:51], v[36:39]
buffer_load_dwordx4 v[172:175], v3, s[8:11], s36 offen offset:3072 sc1
v_mfma_f32_16x16x32_bf16 v[56:59], v[176:179], a[52:55], v[56:59]
v_mfma_f32_16x16x32_bf16 v[76:79], v[176:179], a[56:59], v[76:79]
v_mfma_f32_16x16x32_bf16 v[96:99], v[176:179], a[60:63], v[96:99]
s_waitcnt vmcnt(22)
v_mfma_f32_16x16x32_bf16 v[40:43], v[180:183], a[48:51], v[40:43]
s_add_u32 s37, s37, 8192
buffer_load_dwordx4 v[176:179], v2, s[8:11], s37 offen offset:0 sc1
v_mfma_f32_16x16x32_bf16 v[60:63], v[180:183], a[52:55], v[60:63]
v_mfma_f32_16x16x32_bf16 v[80:83], v[180:183], a[56:59], v[80:83]
v_mfma_f32_16x16x32_bf16 v[100:103], v[180:183], a[60:63], v[100:103]
s_waitcnt vmcnt(22)
v_mfma_f32_16x16x32_bf16 v[44:47], v[184:187], a[48:51], v[44:47]
s_add_u32 s38, s38, 8192
buffer_load_dwordx4 v[180:183], v2, s[8:11], s38 offen offset:0 sc1
v_mfma_f32_16x16x32_bf16 v[64:67], v[184:187], a[52:55], v[64:67]
v_mfma_f32_16x16x32_bf16 v[84:87], v[184:187], a[56:59], v[84:87]
v_mfma_f32_16x16x32_bf16 v[104:107], v[184:187], a[60:63], v[104:107]
s_waitcnt vmcnt(22)
v_mfma_f32_16x16x32_bf16 v[48:51], v[188:191], a[48:51], v[48:51]
s_add_u32 s32, s32, 8192
buffer_load_dwordx4 v[184:187], v2, s[8:11], s32 offen offset:0 sc1
v_mfma_f32_16x16x32_bf16 v[68:71], v[188:191], a[52:55], v[68:71]
v_mfma_f32_16x16x32_bf16 v[88:91], v[188:191], a[56:59], v[88:91]
v_mfma_f32_16x16x32_bf16 v[108:111], v[188:191], a[60:63], v[108:111]
s_waitcnt vmcnt(22)
v_mfma_f32_16x16x32_bf16 v[32:35], v[192:195], a[64:67], v[32:35]
s_add_u32 s33, s33, 8192
buffer_load_dwordx4 v[188:191], v2, s[8:11], s33 offen offset:0 sc1
v_mfma_f32_16x16x32_bf16 v[52:55], v[192:195], a[68:71], v[52:55]
v_mfma_f32_16x16x32_bf16 v[72:75], v[192:195], a[72:75], v[72:75]
v_mfma_f32_16x16x32_bf16 v[92:95], v[192:195], a[76:79], v[92:95]
s_waitcnt vmcnt(22)
v_mfma_f32_16x16x32_bf16 v[36:39], v[196:199], a[64:67], v[36:39]
s_add_u32 s36, s36, 8192
buffer_load_dwordx4 v[192:195], v2, s[8:11], s36 offen offset:0 sc1
v_mfma_f32_16x16x32_bf16 v[56:59], v[196:199], a[68:71], v[56:59]
v_mfma_f32_16x16x32_bf16 v[76:79], v[196:199], a[72:75], v[76:79]
v_mfma_f32_16x16x32_bf16 v[96:99], v[196:199], a[76:79], v[96:99]
s_waitcnt vmcnt(22)
v_mfma_f32_16x16x32_bf16 v[40:43], v[200:203], a[64:67], v[40:43]
buffer_load_dwordx4 v[196:199], v2, s[8:11], s37 offen offset:1024 sc1
v_mfma_f32_16x16x32_bf16 v[60:63], v[200:203], a[68:71], v[60:63]
v_mfma_f32_16x16x32_bf16 v[80:83], v[200:203], a[72:75], v[80:83]
v_mfma_f32_16x16x32_bf16 v[100:103], v[200:203], a[76:79], v[100:103]
s_waitcnt vmcnt(22)
v_mfma_f32_16x16x32_bf16 v[44:47], v[204:207], a[64:67], v[44:47]
buffer_load_dwordx4 v[200:203], v2, s[8:11], s38 offen offset:1024 sc1
v_mfma_f32_16x16x32_bf16 v[64:67], v[204:207], a[68:71], v[64:67]
v_mfma_f32_16x16x32_bf16 v[84:87], v[204:207], a[72:75], v[84:87]
v_mfma_f32_16x16x32_bf16 v[104:107], v[204:207], a[76:79], v[104:107]
s_waitcnt vmcnt(22)
v_mfma_f32_16x16x32_bf16 v[48:51], v[112:115], a[64:67], v[48:51]
buffer_load_dwordx4 v[204:207], v2, s[8:11], s32 offen offset:1024 sc1
v_mfma_f32_16x16x32_bf16 v[68:71], v[112:115], a[68:71], v[68:71]
v_mfma_f32_16x16x32_bf16 v[88:91], v[112:115], a[72:75], v[88:91]
v_mfma_f32_16x16x32_bf16 v[108:111], v[112:115], a[76:79], v[108:111]
s_waitcnt vmcnt(22)
v_mfma_f32_16x16x32_bf16 v[32:35], v[116:119], a[80:83], v[32:35]
buffer_load_dwordx4 v[112:115], v2, s[8:11], s33 offen offset:1024 sc1
v_mfma_f32_16x16x32_bf16 v[52:55], v[116:119], a[84:87], v[52:55]
v_mfma_f32_16x16x32_bf16 v[72:75], v[116:119], a[88:91], v[72:75]
v_mfma_f32_16x16x32_bf16 v[92:95], v[116:119], a[92:95], v[92:95]
s_waitcnt vmcnt(22)
v_mfma_f32_16x16x32_bf16 v[36:39], v[120:123], a[80:83], v[36:39]
buffer_load_dwordx4 v[116:119], v2, s[8:11], s36 offen offset:1024 sc1
v_mfma_f32_16x16x32_bf16 v[56:59], v[120:123], a[84:87], v[56:59]
v_mfma_f32_16x16x32_bf16 v[76:79], v[120:123], a[88:91], v[76:79]
v_mfma_f32_16x16x32_bf16 v[96:99], v[120:123], a[92:95], v[96:99]
s_waitcnt vmcnt(22)
v_mfma_f32_16x16x32_bf16 v[40:43], v[124:127], a[80:83], v[40:43]
buffer_load_dwordx4 v[120:123], v2, s[8:11], s37 offen offset:2048 sc1
v_mfma_f32_16x16x32_bf16 v[60:63], v[124:127], a[84:87], v[60:63]
v_mfma_f32_16x16x32_bf16 v[80:83], v[124:127], a[88:91], v[80:83]
v_mfma_f32_16x16x32_bf16 v[100:103], v[124:127], a[92:95], v[100:103]
s_waitcnt vmcnt(22)
s_waitcnt lgkmcnt(0)
s_barrier
v_mfma_f32_16x16x32_bf16 v[44:47], v[128:131], a[80:83], v[44:47]
buffer_load_dwordx4 v[124:127], v2, s[8:11], s38 offen offset:2048 sc1
v_mfma_f32_16x16x32_bf16 v[64:67], v[128:131], a[84:87], v[64:67]
v_mfma_f32_16x16x32_bf16 v[84:87], v[128:131], a[88:91], v[84:87]
v_mfma_f32_16x16x32_bf16 v[104:107], v[128:131], a[92:95], v[104:107]
s_waitcnt vmcnt(22)
v_mfma_f32_16x16x32_bf16 v[48:51], v[132:135], a[80:83], v[48:51]
buffer_load_dwordx4 v[128:131], v2, s[8:11], s32 offen offset:2048 sc1
v_mfma_f32_16x16x32_bf16 v[68:71], v[132:135], a[84:87], v[68:71]
v_mfma_f32_16x16x32_bf16 v[88:91], v[132:135], a[88:91], v[88:91]
v_mfma_f32_16x16x32_bf16 v[108:111], v[132:135], a[92:95], v[108:111]
s_waitcnt vmcnt(22)
v_mfma_f32_16x16x32_bf16 v[32:35], v[136:139], a[96:99], v[32:35]
buffer_load_dwordx4 v[132:135], v2, s[8:11], s33 offen offset:2048 sc1
v_mfma_f32_16x16x32_bf16 v[52:55], v[136:139], a[100:103], v[52:55]
v_mfma_f32_16x16x32_bf16 v[72:75], v[136:139], a[104:107], v[72:75]
v_mfma_f32_16x16x32_bf16 v[92:95], v[136:139], a[108:111], v[92:95]
s_waitcnt vmcnt(22)
v_mfma_f32_16x16x32_bf16 v[36:39], v[140:143], a[96:99], v[36:39]
buffer_load_dwordx4 v[136:139], v2, s[8:11], s36 offen offset:2048 sc1
v_mfma_f32_16x16x32_bf16 v[56:59], v[140:143], a[100:103], v[56:59]
v_mfma_f32_16x16x32_bf16 v[76:79], v[140:143], a[104:107], v[76:79]
v_mfma_f32_16x16x32_bf16 v[96:99], v[140:143], a[108:111], v[96:99]
s_waitcnt vmcnt(22)
v_mfma_f32_16x16x32_bf16 v[40:43], v[144:147], a[96:99], v[40:43]
buffer_load_dwordx4 v[140:143], v2, s[8:11], s37 offen offset:3072 sc1
v_mfma_f32_16x16x32_bf16 v[60:63], v[144:147], a[100:103], v[60:63]
v_mfma_f32_16x16x32_bf16 v[80:83], v[144:147], a[104:107], v[80:83]
v_mfma_f32_16x16x32_bf16 v[100:103], v[144:147], a[108:111], v[100:103]
s_waitcnt vmcnt(22)
v_mfma_f32_16x16x32_bf16 v[44:47], v[148:151], a[96:99], v[44:47]
buffer_load_dwordx4 v[144:147], v2, s[8:11], s38 offen offset:3072 sc1
v_mfma_f32_16x16x32_bf16 v[64:67], v[148:151], a[100:103], v[64:67]
v_mfma_f32_16x16x32_bf16 v[84:87], v[148:151], a[104:107], v[84:87]
v_mfma_f32_16x16x32_bf16 v[104:107], v[148:151], a[108:111], v[104:107]
s_waitcnt vmcnt(22)
v_mfma_f32_16x16x32_bf16 v[48:51], v[152:155], a[96:99], v[48:51]
buffer_load_dwordx4 v[148:151], v2, s[8:11], s32 offen offset:3072 sc1
v_mfma_f32_16x16x32_bf16 v[68:71], v[152:155], a[100:103], v[68:71]
v_mfma_f32_16x16x32_bf16 v[88:91], v[152:155], a[104:107], v[88:91]
v_mfma_f32_16x16x32_bf16 v[108:111], v[152:155], a[108:111], v[108:111]
s_waitcnt vmcnt(22)
v_mfma_f32_16x16x32_bf16 v[32:35], v[156:159], a[112:115], v[32:35]
buffer_load_dwordx4 v[152:155], v2, s[8:11], s33 offen offset:3072 sc1
v_mfma_f32_16x16x32_bf16 v[52:55], v[156:159], a[116:119], v[52:55]
v_mfma_f32_16x16x32_bf16 v[72:75], v[156:159], a[120:123], v[72:75]
v_mfma_f32_16x16x32_bf16 v[92:95], v[156:159], a[124:127], v[92:95]
s_waitcnt vmcnt(22)
v_mfma_f32_16x16x32_bf16 v[36:39], v[160:163], a[112:115], v[36:39]
buffer_load_dwordx4 v[156:159], v2, s[8:11], s36 offen offset:3072 sc1
v_mfma_f32_16x16x32_bf16 v[56:59], v[160:163], a[116:119], v[56:59]
v_mfma_f32_16x16x32_bf16 v[76:79], v[160:163], a[120:123], v[76:79]
v_mfma_f32_16x16x32_bf16 v[96:99], v[160:163], a[124:127], v[96:99]
s_waitcnt vmcnt(22)
v_mfma_f32_16x16x32_bf16 v[40:43], v[164:167], a[112:115], v[40:43]
s_mul_i32 s31, s20, 3072
s_add_u32 s30, s29, s31
s_add_u32 m0, s31, 0
s_add_u32 s34, s30, 0
buffer_load_dwordx4 v13, s[8:11], s34 offen offset:0 sc1 lds
v_mfma_f32_16x16x32_bf16 v[60:63], v[164:167], a[116:119], v[60:63]
v_mfma_f32_16x16x32_bf16 v[80:83], v[164:167], a[120:123], v[80:83]
v_mfma_f32_16x16x32_bf16 v[100:103], v[164:167], a[124:127], v[100:103]
s_waitcnt vmcnt(22)
v_mfma_f32_16x16x32_bf16 v[44:47], v[168:171], a[112:115], v[44:47]
buffer_load_dwordx4 v13, s[8:11], s34 offen offset:1024 sc1 lds
v_mfma_f32_16x16x32_bf16 v[64:67], v[168:171], a[116:119], v[64:67]
v_mfma_f32_16x16x32_bf16 v[84:87], v[168:171], a[120:123], v[84:87]
v_mfma_f32_16x16x32_bf16 v[104:107], v[168:171], a[124:127], v[104:107]
s_waitcnt vmcnt(22)
v_mfma_f32_16x16x32_bf16 v[48:51], v[172:175], a[112:115], v[48:51]
buffer_load_dwordx4 v13, s[8:11], s34 offen offset:2048 sc1 lds
v_mfma_f32_16x16x32_bf16 v[68:71], v[172:175], a[116:119], v[68:71]
v_mfma_f32_16x16x32_bf16 v[88:91], v[172:175], a[120:123], v[88:91]
v_mfma_f32_16x16x32_bf16 v[108:111], v[172:175], a[124:127], v[108:111]
s_waitcnt vmcnt(22)
v_mfma_f32_16x16x32_bf16 v[32:35], v[176:179], a[128:131], v[32:35]
s_add_u32 m0, s31, 12288
s_add_u32 s34, s30, 12288
buffer_load_dwordx4 v13, s[8:11], s34 offen offset:0 sc1 lds
v_mfma_f32_16x16x32_bf16 v[52:55], v[176:179], a[132:135], v[52:55]
v_mfma_f32_16x16x32_bf16 v[72:75], v[176:179], a[136:139], v[72:75]
v_mfma_f32_16x16x32_bf16 v[92:95], v[176:179], a[140:143], v[92:95]
s_waitcnt vmcnt(22)
v_mfma_f32_16x16x32_bf16 v[36:39], v[180:183], a[128:131], v[36:39]
buffer_load_dwordx4 v13, s[8:11], s34 offen offset:1024 sc1 lds
v_mfma_f32_16x16x32_bf16 v[56:59], v[180:183], a[132:135], v[56:59]
v_mfma_f32_16x16x32_bf16 v[76:79], v[180:183], a[136:139], v[76:79]
v_mfma_f32_16x16x32_bf16 v[96:99], v[180:183], a[140:143], v[96:99]
s_waitcnt vmcnt(22)
v_mfma_f32_16x16x32_bf16 v[40:43], v[184:187], a[128:131], v[40:43]
buffer_load_dwordx4 v13, s[8:11], s34 offen offset:2048 sc1 lds
v_mfma_f32_16x16x32_bf16 v[60:63], v[184:187], a[132:135], v[60:63]
v_mfma_f32_16x16x32_bf16 v[80:83], v[184:187], a[136:139], v[80:83]
v_mfma_f32_16x16x32_bf16 v[100:103], v[184:187], a[140:143], v[100:103]
s_waitcnt vmcnt(22)
v_mfma_f32_16x16x32_bf16 v[44:47], v[188:191], a[128:131], v[44:47]
s_add_u32 m0, s31, 24576
s_add_u32 s34, s30, 24576
buffer_load_dwordx4 v13, s[8:11], s34 offen offset:0 sc1 lds
v_mfma_f32_16x16x32_bf16 v[64:67], v[188:191], a[132:135], v[64:67]
v_mfma_f32_16x16x32_bf16 v[84:87], v[188:191], a[136:139], v[84:87]
v_mfma_f32_16x16x32_bf16 v[104:107], v[188:191], a[140:143], v[104:107]
s_waitcnt vmcnt(22)
v_mfma_f32_16x16x32_bf16 v[48:51], v[192:195], a[128:131], v[48:51]
buffer_load_dwordx4 v13, s[8:11], s34 offen offset:1024 sc1 lds
v_mfma_f32_16x16x32_bf16 v[68:71], v[192:195], a[132:135], v[68:71]
v_mfma_f32_16x16x32_bf16 v[88:91], v[192:195], a[136:139], v[88:91]
v_mfma_f32_16x16x32_bf16 v[108:111], v[192:195], a[140:143], v[108:111]
s_waitcnt vmcnt(22)
v_mfma_f32_16x16x32_bf16 v[32:35], v[196:199], a[144:147], v[32:35]
buffer_load_dwordx4 v13, s[8:11], s34 offen offset:2048 sc1 lds
v_mfma_f32_16x16x32_bf16 v[52:55], v[196:199], a[148:151], v[52:55]
v_mfma_f32_16x16x32_bf16 v[72:75], v[196:199], a[152:155], v[72:75]
v_mfma_f32_16x16x32_bf16 v[92:95], v[196:199], a[156:159], v[92:95]
s_waitcnt vmcnt(22)
v_mfma_f32_16x16x32_bf16 v[36:39], v[200:203], a[144:147], v[36:39]
s_add_u32 m0, s31, 36864
s_add_u32 s34, s30, 36864
buffer_load_dwordx4 v13, s[8:11], s34 offen offset:0 sc1 lds
v_mfma_f32_16x16x32_bf16 v[56:59], v[200:203], a[148:151], v[56:59]
v_mfma_f32_16x16x32_bf16 v[76:79], v[200:203], a[152:155], v[76:79]
v_mfma_f32_16x16x32_bf16 v[96:99], v[200:203], a[156:159], v[96:99]
s_waitcnt vmcnt(22)
v_mfma_f32_16x16x32_bf16 v[40:43], v[204:207], a[144:147], v[40:43]
buffer_load_dwordx4 v13, s[8:11], s34 offen offset:1024 sc1 lds
v_mfma_f32_16x16x32_bf16 v[60:63], v[204:207], a[148:151], v[60:63]
v_mfma_f32_16x16x32_bf16 v[80:83], v[204:207], a[152:155], v[80:83]
v_mfma_f32_16x16x32_bf16 v[100:103], v[204:207], a[156:159], v[100:103]
s_waitcnt vmcnt(22)
v_mfma_f32_16x16x32_bf16 v[44:47], v[112:115], a[144:147], v[44:47]
buffer_load_dwordx4 v13, s[8:11], s34 offen offset:2048 sc1 lds
v_mfma_f32_16x16x32_bf16 v[64:67], v[112:115], a[148:151], v[64:67]
v_mfma_f32_16x16x32_bf16 v[84:87], v[112:115], a[152:155], v[84:87]
v_mfma_f32_16x16x32_bf16 v[104:107], v[112:115], a[156:159], v[104:107]
s_waitcnt vmcnt(22)
v_mfma_f32_16x16x32_bf16 v[48:51], v[116:119], a[144:147], v[48:51]
s_add_u32 m0, s31, 49152
s_add_u32 s34, s30, 49152
buffer_load_dwordx4 v13, s[8:11], s34 offen offset:0 sc1 lds
v_mfma_f32_16x16x32_bf16 v[68:71], v[116:119], a[148:151], v[68:71]
v_mfma_f32_16x16x32_bf16 v[88:91], v[116:119], a[152:155], v[88:91]
v_mfma_f32_16x16x32_bf16 v[108:111], v[116:119], a[156:159], v[108:111]
s_waitcnt vmcnt(22)
v_mfma_f32_16x16x32_bf16 v[32:35], v[120:123], a[160:163], v[32:35]
buffer_load_dwordx4 v13, s[8:11], s34 offen offset:1024 sc1 lds
v_mfma_f32_16x16x32_bf16 v[52:55], v[120:123], a[164:167], v[52:55]
v_mfma_f32_16x16x32_bf16 v[72:75], v[120:123], a[168:171], v[72:75]
v_mfma_f32_16x16x32_bf16 v[92:95], v[120:123], a[172:175], v[92:95]
s_waitcnt vmcnt(22)
v_mfma_f32_16x16x32_bf16 v[36:39], v[124:127], a[160:163], v[36:39]
buffer_load_dwordx4 v13, s[8:11], s34 offen offset:2048 sc1 lds
v_mfma_f32_16x16x32_bf16 v[56:59], v[124:127], a[164:167], v[56:59]
v_mfma_f32_16x16x32_bf16 v[76:79], v[124:127], a[168:171], v[76:79]
v_mfma_f32_16x16x32_bf16 v[96:99], v[124:127], a[172:175], v[96:99]
s_waitcnt vmcnt(22)
v_mfma_f32_16x16x32_bf16 v[40:43], v[128:131], a[160:163], v[40:43]
s_add_u32 m0, s31, 61440
s_add_u32 s34, s30, 61440
buffer_load_dwordx4 v13, s[8:11], s34 offen offset:0 sc1 lds
v_mfma_f32_16x16x32_bf16 v[60:63], v[128:131], a[164:167], v[60:63]
v_mfma_f32_16x16x32_bf16 v[80:83], v[128:131], a[168:171], v[80:83]
v_mfma_f32_16x16x32_bf16 v[100:103], v[128:131], a[172:175], v[100:103]
s_waitcnt vmcnt(22)
v_mfma_f32_16x16x32_bf16 v[44:47], v[132:135], a[160:163], v[44:47]
buffer_load_dwordx4 v13, s[8:11], s34 offen offset:1024 sc1 lds
v_mfma_f32_16x16x32_bf16 v[64:67], v[132:135], a[164:167], v[64:67]
v_mfma_f32_16x16x32_bf16 v[84:87], v[132:135], a[168:171], v[84:87]
v_mfma_f32_16x16x32_bf16 v[104:107], v[132:135], a[172:175], v[104:107]
s_waitcnt vmcnt(22)
v_mfma_f32_16x16x32_bf16 v[48:51], v[136:139], a[160:163], v[48:51]
buffer_load_dwordx4 v13, s[8:11], s34 offen offset:2048 sc1 lds
v_mfma_f32_16x16x32_bf16 v[68:71], v[136:139], a[164:167], v[68:71]
v_mfma_f32_16x16x32_bf16 v[88:91], v[136:139], a[168:171], v[88:91]
v_mfma_f32_16x16x32_bf16 v[108:111], v[136:139], a[172:175], v[108:111]
s_waitcnt vmcnt(22)
v_mfma_f32_16x16x32_bf16 v[32:35], v[140:143], a[176:179], v[32:35]
s_add_u32 m0, s31, 73728
s_add_u32 s34, s30, 73728
buffer_load_dwordx4 v13, s[8:11], s34 offen offset:0 sc1 lds
v_mfma_f32_16x16x32_bf16 v[52:55], v[140:143], a[180:183], v[52:55]
v_mfma_f32_16x16x32_bf16 v[72:75], v[140:143], a[184:187], v[72:75]
v_mfma_f32_16x16x32_bf16 v[92:95], v[140:143], a[188:191], v[92:95]
s_waitcnt vmcnt(22)
v_mfma_f32_16x16x32_bf16 v[36:39], v[144:147], a[176:179], v[36:39]
buffer_load_dwordx4 v13, s[8:11], s34 offen offset:1024 sc1 lds
v_mfma_f32_16x16x32_bf16 v[56:59], v[144:147], a[180:183], v[56:59]
v_mfma_f32_16x16x32_bf16 v[76:79], v[144:147], a[184:187], v[76:79]
v_mfma_f32_16x16x32_bf16 v[96:99], v[144:147], a[188:191], v[96:99]
s_waitcnt vmcnt(22)
v_mfma_f32_16x16x32_bf16 v[40:43], v[148:151], a[176:179], v[40:43]
buffer_load_dwordx4 v13, s[8:11], s34 offen offset:2048 sc1 lds
v_mfma_f32_16x16x32_bf16 v[60:63], v[148:151], a[180:183], v[60:63]
v_mfma_f32_16x16x32_bf16 v[80:83], v[148:151], a[184:187], v[80:83]
v_mfma_f32_16x16x32_bf16 v[100:103], v[148:151], a[188:191], v[100:103]
s_waitcnt vmcnt(22)
v_mfma_f32_16x16x32_bf16 v[44:47], v[152:155], a[176:179], v[44:47]
s_add_u32 m0, s31, 86016
s_add_u32 s34, s30, 86016
buffer_load_dwordx4 v13, s[8:11], s34 offen offset:0 sc1 lds
v_mfma_f32_16x16x32_bf16 v[64:67], v[152:155], a[180:183], v[64:67]
v_mfma_f32_16x16x32_bf16 v[84:87], v[152:155], a[184:187], v[84:87]
v_mfma_f32_16x16x32_bf16 v[104:107], v[152:155], a[188:191], v[104:107]
s_waitcnt vmcnt(22)
v_mfma_f32_16x16x32_bf16 v[48:51], v[156:159], a[176:179], v[48:51]
buffer_load_dwordx4 v13, s[8:11], s34 offen offset:1024 sc1 lds
v_mfma_f32_16x16x32_bf16 v[68:71], v[156:159], a[180:183], v[68:71]
v_mfma_f32_16x16x32_bf16 v[88:91], v[156:159], a[184:187], v[88:91]
v_mfma_f32_16x16x32_bf16 v[108:111], v[156:159], a[188:191], v[108:111]
ds_write_b128 v8, v[52:55] offset:0
buffer_load_dwordx4 v13, s[8:11], s34 offen offset:2048 sc1 lds
ds_write_b128 v8, v[56:59] offset:1024
ds_write_b128 v8, v[60:63] offset:2048
ds_write_b128 v8, v[64:67] offset:3072
s_nop 0
ds_write_b128 v8, v[68:71] offset:4096
ds_write_b128 v9, v[72:75] offset:0
ds_write_b128 v9, v[76:79] offset:1024
ds_write_b128 v9, v[80:83] offset:2048
ds_write_b128 v9, v[84:87] offset:3072
ds_write_b128 v9, v[88:91] offset:4096
ds_write_b128 v10, v[92:95] offset:0
ds_write_b128 v10, v[96:99] offset:1024
ds_write_b128 v10, v[100:103] offset:2048
ds_write_b128 v10, v[104:107] offset:3072
ds_write_b128 v10, v[108:111] offset:4096
s_waitcnt lgkmcnt(0)
s_barrier
ds_read_b128 v[132:135], v11 offset:0
ds_read_b128 v[136:139], v11 offset:1024
ds_read_b128 v[140:143], v11 offset:2048
ds_read_b128 v[144:147], v11 offset:3072
ds_read_b128 v[148:151], v11 offset:4096
ds_read_b128 v[152:155], v11 offset:5120
ds_read_b128 v[156:159], v11 offset:6144
ds_read_b128 v[160:163], v11 offset:7168
ds_read_b128 v[164:167], v11 offset:8192
ds_read_b128 v[168:171], v11 offset:9216
ds_read_b128 v[172:175], v11 offset:10240
ds_read_b128 v[176:179], v11 offset:11264
ds_read_b128 v[180:183], v11 offset:12288
ds_read_b128 v[184:187], v11 offset:13312
ds_read_b128 v[188:191], v11 offset:14336
s_waitcnt lgkmcnt(10)
v_pk_add_f32 v[112:113], v[32:33], v[132:133]
v_pk_add_f32 v[114:115], v[34:35], v[134:135]
v_pk_add_f32 v[116:117], v[36:37], v[136:137]
v_pk_add_f32 v[118:119], v[38:39], v[138:139]
v_pk_add_f32 v[120:121], v[40:41], v[140:141]
v_pk_add_f32 v[122:123], v[42:43], v[142:143]
v_pk_add_f32 v[124:125], v[44:45], v[144:145]
v_pk_add_f32 v[126:127], v[46:47], v[146:147]
v_pk_add_f32 v[128:129], v[48:49], v[148:149]
v_pk_add_f32 v[130:131], v[50:51], v[150:151]
s_waitcnt lgkmcnt(5)
v_pk_add_f32 v[112:113], v[112:113], v[152:153]
v_pk_add_f32 v[114:115], v[114:115], v[154:155]
v_pk_add_f32 v[116:117], v[116:117], v[156:157]
v_pk_add_f32 v[118:119], v[118:119], v[158:159]
v_pk_add_f32 v[120:121], v[120:121], v[160:161]
v_pk_add_f32 v[122:123], v[122:123], v[162:163]
v_pk_add_f32 v[124:125], v[124:125], v[164:165]
v_pk_add_f32 v[126:127], v[126:127], v[166:167]
v_pk_add_f32 v[128:129], v[128:129], v[168:169]
v_pk_add_f32 v[130:131], v[130:131], v[170:171]
s_waitcnt lgkmcnt(0)
v_pk_add_f32 v[112:113], v[112:113], v[172:173]
v_pk_add_f32 v[114:115], v[114:115], v[174:175]
v_pk_add_f32 v[116:117], v[116:117], v[176:177]
v_pk_add_f32 v[118:119], v[118:119], v[178:179]
v_pk_add_f32 v[120:121], v[120:121], v[180:181]
v_pk_add_f32 v[122:123], v[122:123], v[182:183]
v_pk_add_f32 v[124:125], v[124:125], v[184:185]
v_pk_add_f32 v[126:127], v[126:127], v[186:187]
v_pk_add_f32 v[128:129], v[128:129], v[188:189]
v_pk_add_f32 v[130:131], v[130:131], v[190:191]
v_pk_add_f32 v[112:113], v[112:113], v[12:13] op_sel_hi:[1,0]
v_pk_add_f32 v[114:115], v[114:115], v[12:13] op_sel_hi:[1,0]
v_pk_add_f32 v[116:117], v[116:117], v[12:13] op_sel_hi:[1,0]
v_pk_add_f32 v[118:119], v[118:119], v[12:13] op_sel_hi:[1,0]
v_pk_add_f32 v[120:121], v[120:121], v[12:13] op_sel_hi:[1,0]
v_pk_add_f32 v[122:123], v[122:123], v[12:13] op_sel_hi:[1,0]
v_pk_add_f32 v[124:125], v[124:125], v[12:13] op_sel_hi:[1,0]
v_pk_add_f32 v[126:127], v[126:127], v[12:13] op_sel_hi:[1,0]
v_pk_add_f32 v[128:129], v[128:129], v[12:13] op_sel_hi:[1,0]
v_pk_add_f32 v[130:131], v[130:131], v[12:13] op_sel_hi:[1,0]
v_cvt_pk_bf16_f32 v244, v112, v113
v_cvt_pk_bf16_f32 v245, v114, v115
v_cvt_pk_bf16_f32 v246, v116, v117
v_cvt_pk_bf16_f32 v247, v118, v119
v_cvt_pk_bf16_f32 v248, v120, v121
v_cvt_pk_bf16_f32 v249, v122, v123
v_cvt_pk_bf16_f32 v250, v124, v125
v_cvt_pk_bf16_f32 v251, v126, v127
v_cvt_pk_bf16_f32 v252, v128, v129
v_cvt_pk_bf16_f32 v253, v130, v131
s_cmp_eq_u32 s28, 1
s_cbranch_scc1 mn_final
s_add_u32 s27, s27, 13631488
v_lshrrev_b32 v14, 1, v5
v_lshlrev_b32 v14, 9, v14
v_lshl_add_u32 v14, v4, 4, v14
v_and_b32 v15, 1, v5
v_lshl_add_u32 v14, v15, 3, v14
s_lshr_b32 s3, s20, 1
s_lshl_b32 s36, s23, 1
s_add_u32 s36, s36, s3
s_and_b32 s37, s20, 1
s_mul_i32 s3, s36, 40960
s_mul_i32 s4, s24, 5120
s_add_u32 s3, s3, s4
s_lshl_b32 s4, s37, 8
s_add_u32 s3, s3, s4
s_add_u32 s7, s3, s27
buffer_store_dwordx2 v[244:245], v14, s[8:11], s7 offen sc1
buffer_store_dwordx2 v[246:247], v14, s[8:11], s7 offen offset:1024 sc1
buffer_store_dwordx2 v[248:249], v14, s[8:11], s7 offen offset:2048 sc1
buffer_store_dwordx2 v[250:251], v14, s[8:11], s7 offen offset:3072 sc1
s_add_u32 s99, s7, 4096
buffer_store_dwordx2 v[252:253], v14, s[8:11], s99 offen sc1
v_pk_add_f32 v[32:33], v[112:113], v[114:115]
v_pk_mul_f32 v[34:35], v[112:113], v[112:113]
v_pk_add_f32 v[36:37], v[116:117], v[118:119]
v_pk_mul_f32 v[38:39], v[114:115], v[114:115]
v_pk_fma_f32 v[34:35], v[116:117], v[116:117], v[34:35]
v_pk_fma_f32 v[38:39], v[118:119], v[118:119], v[38:39]
v_pk_add_f32 v[32:33], v[32:33], v[120:121]
v_pk_fma_f32 v[34:35], v[120:121], v[120:121], v[34:35]
v_pk_add_f32 v[36:37], v[36:37], v[122:123]
v_pk_fma_f32 v[38:39], v[122:123], v[122:123], v[38:39]
v_pk_add_f32 v[32:33], v[32:33], v[124:125]
v_pk_fma_f32 v[34:35], v[124:125], v[124:125], v[34:35]
v_pk_add_f32 v[36:37], v[36:37], v[126:127]
v_pk_fma_f32 v[38:39], v[126:127], v[126:127], v[38:39]
v_pk_add_f32 v[32:33], v[32:33], v[128:129]
v_pk_fma_f32 v[34:35], v[128:129], v[128:129], v[34:35]
v_pk_add_f32 v[36:37], v[36:37], v[130:131]
v_pk_fma_f32 v[38:39], v[130:131], v[130:131], v[38:39]
v_pk_add_f32 v[32:33], v[32:33], v[36:37]
v_pk_add_f32 v[34:35], v[34:35], v[38:39]
v_add_f32 v32, v32, v33
v_add_f32 v34, v34, v35
v_mov_b32 v33, v32
v_mov_b32 v35, v34
s_nop 0
v_permlane16_swap_b32 v32, v33
v_permlane16_swap_b32 v34, v35
v_add_f32 v32, v32, v33
v_add_f32 v34, v34, v35
v_mov_b32 v33, v32
v_mov_b32 v35, v34
s_nop 0
v_permlane32_swap_b32 v32, v33
v_permlane32_swap_b32 v34, v35
v_add_f32 v32, v32, v33
v_add_f32 v34, v34, v35
v_cmp_eq_u32 vcc, 1, v5
s_nop 1
v_cndmask_b32 v32, v32, v34, vcc
v_lshlrev_b32 v14, 3, v4
v_lshl_add_u32 v14, v5, 2, v14
s_lshl_b32 s3, s35, 2
s_add_u32 s3, s3, s27
s_add_u32 s3, s3, 12451840
s_mov_b32 exec_hi, 0
buffer_atomic_add_f32 v32, v14, s[8:11], s3 offen sc1
s_mov_b64 exec, -1
s_lshl_b32 s3, s23, 3
s_add_u32 s3, s3, s24
s_lshl_b32 s3, s3, 7
s_add_u32 s3, s3, s27
s_add_u32 s6, s3, 12566528
s_waitcnt vmcnt(0)
s_barrier
s_cmp_lg_u32 s20, 0
s_cbranch_scc1 mn_nf19
s_mov_b64 exec, 1
v_mov_b32 v30, s69
buffer_store_dword v30, v255, s[8:11], s6 offen sc1
s_mov_b64 exec, -1
mn_nf19:
s_lshr_b32 s3, s2, 3
s_mul_i32 s3, s3, 15360
s_mul_i32 s4, s20, 1572864
s_add_u32 s3, s3, s4
s_bfe_u32 s4, s2, 0x20001
s_min_u32 s5, s4, 2
s_lshl_b32 s5, s5, 10
s_add_u32 s3, s3, s5
s_add_u32 s3, s3, 384
s_cmp_eq_u32 s4, 2
s_cselect_b32 s4, 0, 5
v_mul_u32_u24 v26, 3072, v1
v_cmp_gt_u32 vcc, s4, v1
s_nop 1
v_cndmask_b32 v26, v254, v26, vcc
buffer_load_dword v27, v26, s[60:63], s3 offen
s_mul_i32 s31, s20, 3072
s_add_u32 s30, s29, s31
s_add_u32 m0, s31, 98304
s_add_u32 s34, s30, 98304
buffer_load_dwordx4 v13, s[8:11], s34 offen offset:0 sc1 lds
buffer_load_dwordx4 v13, s[8:11], s34 offen offset:1024 sc1 lds
buffer_load_dwordx4 v13, s[8:11], s34 offen offset:2048 sc1 lds
s_add_u32 m0, s31, 110592
s_add_u32 s34, s30, 110592
buffer_load_dwordx4 v13, s[8:11], s34 offen offset:0 sc1 lds
buffer_load_dwordx4 v13, s[8:11], s34 offen offset:1024 sc1 lds
buffer_load_dwordx4 v13, s[8:11], s34 offen offset:2048 sc1 lds
s_mul_i32 s31, s20, 10240
s_add_u32 s30, s29, s31
s_add_u32 m0, s31, 122880
s_add_u32 s34, s30, 122880
buffer_load_dwordx4 v13, s[8:11], s34 offen offset:0 sc1 lds
buffer_load_dwordx4 v13, s[8:11], s34 offen offset:1024 sc1 lds
buffer_load_dwordx4 v13, s[8:11], s34 offen offset:2048 sc1 lds
buffer_load_dwordx4 v13, s[8:11], s34 offen offset:3072 sc1 lds
s_add_u32 m0, s31, 126976
s_add_u32 s34, s30, 126976
buffer_load_dwordx4 v13, s[8:11], s34 offen offset:0 sc1 lds
buffer_load_dwordx4 v13, s[8:11], s34 offen offset:1024 sc1 lds
buffer_load_dwordx4 v13, s[8:11], s34 offen offset:2048 sc1 lds
buffer_load_dwordx4 v13, s[8:11], s34 offen offset:3072 sc1 lds
s_add_u32 m0, s31, 131072
s_add_u32 s34, s30, 131072
buffer_load_dwordx4 v13, s[8:11], s34 offen offset:0 sc1 lds
buffer_load_dwordx4 v13, s[8:11], s34 offen offset:1024 sc1 lds
s_mov_b32 s28, 1
s_branch mn_a1
mn_final:
v_mul_u32_u24 v14, 1280, v4
v_lshl_add_u32 v14, v5, 3, v14
s_mul_i32 s3, s35, 640
s_mul_i32 s4, s24, 160
s_add_u32 s3, s3, s4
buffer_store_dwordx2 v[244:245], v14, s[40:43], s3 offen offset:0
buffer_store_dwordx2 v[246:247], v14, s[40:43], s3 offen offset:32
buffer_store_dwordx2 v[248:249], v14, s[40:43], s3 offen offset:64
buffer_store_dwordx2 v[250:251], v14, s[40:43], s3 offen offset:96
buffer_store_dwordx2 v[252:253], v14, s[40:43], s3 offen offset:128
s_add_u32 s3, s2, s20
s_cmp_lg_u32 s3, 0
s_cbranch_scc1 mn_noep
s_mov_b64 exec, 1
v_mov_b32 v30, s69
s_mov_b32 s3, 16826368
buffer_store_dword v30, v255, s[8:11], s3 offen sc1
s_mov_b64 exec, -1
mn_noep:
mn_end:
s_endpgm
.section .rodata,"a"
.p2align 6
.amdhsa_kernel interleave_layers__linear_kernel_hedgehog__mixer_token_mlp__prompt_kernel
  .amdhsa_next_free_vgpr 512
  .amdhsa_next_free_sgpr 102
  .amdhsa_accum_offset 256
  .amdhsa_group_segment_fixed_size 0
  .amdhsa_kernarg_size 96
  .amdhsa_user_sgpr_count 2
  .amdhsa_user_sgpr_kernarg_segment_ptr 1
  .amdhsa_system_sgpr_workgroup_id_x 1
.end_amdhsa_kernel
```
